```python
import torch

def _softmax(x, axis=-1):
    return torch.softmax(x, dim=axis)
def _gelu(x):
    return torch.nn.functional.gelu(x, approximate="tanh")
def _silu(x):
    return torch.nn.functional.silu(x)
def _sigmoid(x):
    return torch.sigmoid(x)
def _layernorm(x, axis=-1, eps=1e-5):
    m = x.mean(dim=axis, keepdim=True)
    v = x.var(dim=axis, keepdim=True, unbiased=False)
    return (x - m) / torch.sqrt(v + eps)
def _scatter_add(tgt, idx, src, axis=0):
    return tgt.clone().index_add_(axis, idx, src)
def _segment_sum(src, seg, n):
    out = torch.zeros((n,) + src.shape[1:], dtype=src.dtype)
    return out.index_add_(0, seg, src)
def _pad(x, pw):
    flat = tuple(v for pair in reversed(pw) for v in pair)
    return torch.nn.functional.pad(x, flat)

kernel_name = 'interleave_layers__spectral_fnet__geglu_ffn__prompt'

def setup_inputs():

    _w = (lambda a: (lambda t: t.to(torch.bfloat16) if t.is_floating_point() else t)(torch.as_tensor(a)))
    def _A_setup():
        B, S, D = 1, 2048, 512
        ns = torch.arange(S)[:, None] * torch.arange(S)[None, :]
        nd = torch.arange(D)[:, None] * torch.arange(D)[None, :]
        Ws_re = torch.cos(-2.0 * torch.pi * ns / S).to(float)
        Ws_im = torch.sin(-2.0 * torch.pi * ns / S).to(float)
        Wd_re = torch.cos(-2.0 * torch.pi * nd / D).to(float)
        Wd_im = torch.sin(-2.0 * torch.pi * nd / D).to(float)
        return {
            "x": _w((lambda *s: torch.randn(*s, dtype=torch.bfloat16) * 0.05)(B, S, D)),
            "dft_seq_re": _w(Ws_re),
            "dft_seq_im": _w(Ws_im),
            "dft_hid_re": _w(Wd_re),
            "dft_hid_im": _w(Wd_im),
        }
    _A_in = _A_setup()

    def _B_setup():
        B, S, D, F = 1, 2048, 512, 1792
        return {
            "x": _w((lambda *s: torch.randn(*s, dtype=torch.bfloat16) * 0.05)(B, S, D)),
            "w_gate": _w((lambda *s: torch.randn(*s, dtype=torch.bfloat16) * 0.4)(D, F)),
            "w_up": _w((lambda *s: torch.randn(*s, dtype=torch.bfloat16) * 0.4)(D, F)),
            "w_down": _w((lambda *s: torch.randn(*s, dtype=torch.bfloat16) * 0.4)(F, D)),
        }
    _B_in = _B_setup()

    return {
        "A_x": _A_in["x"],
        "A_dft_seq_re": _A_in["dft_seq_re"],
        "A_dft_seq_im": _A_in["dft_seq_im"],
        "A_dft_hid_re": _A_in["dft_hid_re"],
        "A_dft_hid_im": _A_in["dft_hid_im"],
        "B_x": _B_in["x"],
        "B_w_gate": _B_in["w_gate"],
        "B_w_up": _B_in["w_up"],
        "B_w_down": _B_in["w_down"],
    }

def reference(A_x, A_dft_seq_re, A_dft_seq_im, A_dft_hid_re, A_dft_hid_im, B_x, B_w_gate, B_w_up, B_w_down):
    def _A_ref(x, dft_seq_re, dft_seq_im, dft_hid_re, dft_hid_im):
        a = torch.einsum("bsd,ed->bse", x, dft_hid_re)
        b = torch.einsum("bsd,ed->bse", x, dft_hid_im)
        y = torch.einsum("ts,bse->bte", dft_seq_re, a) - torch.einsum("ts,bse->bte", dft_seq_im, b)
        return y

    def _B_ref(x, w_gate, w_up, w_down):
        return (_gelu(x @ w_gate) * (x @ w_up)) @ w_down

    x = A_x
    x = x + _A_ref(_layernorm(x, axis=-1), A_dft_seq_re, A_dft_seq_im, A_dft_hid_re, A_dft_hid_im)
    x = x + _B_ref(_layernorm(x, axis=-1), B_w_gate, B_w_up, B_w_down)
    x = x + _A_ref(_layernorm(x, axis=-1), A_dft_seq_re, A_dft_seq_im, A_dft_hid_re, A_dft_hid_im)
    x = x + _B_ref(_layernorm(x, axis=-1), B_w_gate, B_w_up, B_w_down)
    return x
```

```asm
; @launch kernel=ka0_kernel grid=(256,1,1) block=(256,1,1) lds=139264
; @launch kernel=ks0_kernel grid=(240,1,1) block=(256,1,1) lds=98816
; @launch kernel=kb_kernel grid=(256,1,1) block=(256,1,1) lds=131072
; @launch kernel=kc0_kernel grid=(256,1,1) block=(256,1,1) lds=49152
; @launch kernel=ka1_kernel grid=(256,1,1) block=(256,1,1) lds=139264
; @launch kernel=ks1_kernel grid=(128,1,1) block=(256,1,1) lds=98816
; @launch kernel=kb_kernel grid=(256,1,1) block=(256,1,1) lds=131072
; @launch kernel=kc1_kernel grid=(256,1,1) block=(256,1,1) lds=49152
.amdgcn_target "amdgcn-amd-amdhsa--gfx950"
.text
.p2align 8
.globl ka0_kernel
.type ka0_kernel,@function
ka0_kernel:
    s_mov_b32 s3, 0
    s_branch ka_body
.p2align 8
.globl ka1_kernel
.type ka1_kernel,@function
ka1_kernel:
    s_mov_b32 s3, 1
    s_branch ka_body
ka_body:
    s_load_dwordx16 s[32:47], s[0:1], 0
    s_load_dwordx8 s[48:55], s[0:1], 64
    v_and_b32 v1, 63, v0
    v_lshrrev_b32 v4, 6, v0
    v_and_b32_e64 v2, 15, v0
    v_bfe_u32 v3, v0, 4, 2
    v_readfirstlane_b32 s4, v4
    s_cmp_ge_u32 s2, 32
    s_cbranch_scc1 ka_nopf0
    s_cmp_lg_u32 s3, 0
    s_cbranch_scc1 ka_nopf0
    s_getpc_b64 s[56:57]
ka_pc0:
    s_mov_b32 s58, ks0_kernel-ka_pc0
    s_mov_b32 s59, 0x00020000
    s_lshl_b32 s7, s4, 11
    v_lshl_add_u32 v4, v1, 4, s7
    s_nop 0
    buffer_load_dwordx4 v[204:207], v4, s[56:59], 0 offen
    buffer_load_dwordx4 v[204:207], v4, s[56:59], 0 offen offset:1024
ka_nopf0:
    s_cmp_ge_u32 s2, 256
    s_cbranch_scc1 ka_exit
    s_and_b32 s5, s2, 7
    s_lshl_b32 s5, s5, 2
    s_bfe_u32 s6, s2, 0x20003
    s_add_u32 s5, s5, s6
    s_lshr_b32 s6, s2, 5
    v_and_b32 v4, 15, v1
    v_lshrrev_b32 v5, 4, v1
    s_lshl_b32 s7, s4, 19
    s_lshl_b32 s28, s5, 10
    s_add_u32 s28, s28, s7
    s_and_b32 s7, s4, 1
    s_lshl_b32 s7, s7, 4
    s_lshl_b32 s29, s6, 5
    s_add_u32 s7, s7, s29
    v_mov_b32 v9, 0x100
    v_add_u32 v6, 0, v5
    v_xor_b32 v7, v4, v6
    v_lshlrev_b32_e64 v7, 4, v7
    v_lshl_add_u32 v136, v6, 15, v7
    v_add_u32 v136, s28, v136
    v_add_u32 v6, s7, v6
    v_cmp_eq_u32 vcc, 0, v6
    v_cndmask_b32 v6, v6, v9, vcc
    v_lshl_add_u32 v140, v6, 10, v7
    v_add_u32 v6, 4, v5
    v_xor_b32 v7, v4, v6
    v_lshlrev_b32_e64 v7, 4, v7
    v_lshl_add_u32 v137, v6, 15, v7
    v_add_u32 v137, s28, v137
    v_add_u32 v6, s7, v6
    v_cmp_eq_u32 vcc, 0, v6
    v_cndmask_b32 v6, v6, v9, vcc
    v_lshl_add_u32 v141, v6, 10, v7
    v_add_u32 v6, 8, v5
    v_xor_b32 v7, v4, v6
    v_lshlrev_b32_e64 v7, 4, v7
    v_lshl_add_u32 v138, v6, 15, v7
    v_add_u32 v138, s28, v138
    v_add_u32 v6, s7, v6
    v_cmp_eq_u32 vcc, 0, v6
    v_cndmask_b32 v6, v6, v9, vcc
    v_lshl_add_u32 v142, v6, 10, v7
    v_add_u32 v6, 12, v5
    v_xor_b32 v7, v4, v6
    v_lshlrev_b32_e64 v7, 4, v7
    v_lshl_add_u32 v139, v6, 15, v7
    v_add_u32 v139, s28, v139
    v_add_u32 v6, s7, v6
    v_cmp_eq_u32 vcc, 0, v6
    v_cndmask_b32 v6, v6, v9, vcc
    v_lshl_add_u32 v143, v6, 10, v7
    s_waitcnt lgkmcnt(0)
    s_add_u32 s12, s54, 0xe00000
    s_addc_u32 s13, s55, 0
    s_cmp_eq_u32 s3, 0
    s_cselect_b32 s8, s32, s12
    s_cselect_b32 s9, s33, s13
    s_mov_b32 s10, 0x200000
    s_mov_b32 s11, 0x00020000
    s_cmp_lt_u32 s4, 2
    s_cselect_b32 s12, s38, s40
    s_cselect_b32 s13, s39, s41
    s_mov_b32 s14, 0x80000
    s_mov_b32 s15, 0x00020000
    s_lshl_b32 s30, s4, 12
    s_add_u32 m0, s30, 65536
    s_nop 0
    buffer_load_dwordx4 v140, s[12:15], 0 offen offset:0 lds
    s_add_u32 m0, s30, 0
    s_nop 0
    buffer_load_dwordx4 v136, s[8:11], 0 offen offset:0 lds
    s_add_u32 m0, s30, 66560
    s_nop 0
    s_nop 0
    buffer_load_dwordx4 v141, s[12:15], 0 offen offset:0 lds
    s_add_u32 m0, s30, 1024
    s_nop 0
    s_nop 0
    buffer_load_dwordx4 v137, s[8:11], 0 offen offset:0 lds
    s_add_u32 m0, s30, 67584
    s_nop 0
    s_nop 0
    buffer_load_dwordx4 v142, s[12:15], 0 offen offset:0 lds
    s_add_u32 m0, s30, 2048
    s_nop 0
    s_nop 0
    buffer_load_dwordx4 v138, s[8:11], 0 offen offset:0 lds
    s_add_u32 m0, s30, 68608
    s_nop 0
    s_nop 0
    buffer_load_dwordx4 v143, s[12:15], 0 offen offset:0 lds
    s_add_u32 m0, s30, 3072
    s_nop 0
    s_nop 0
    buffer_load_dwordx4 v139, s[8:11], 0 offen offset:0 lds
    s_add_u32 m0, s30, 81664
    s_nop 0
    s_nop 0
    buffer_load_dwordx4 v140, s[12:15], 0 offen offset:256 lds
    s_add_u32 m0, s30, 16128
    s_nop 0
    s_nop 0
    buffer_load_dwordx4 v136, s[8:11], 0 offen offset:256 lds
    s_add_u32 m0, s30, 82688
    s_nop 0
    s_nop 0
    buffer_load_dwordx4 v141, s[12:15], 0 offen offset:256 lds
    s_add_u32 m0, s30, 17152
    s_nop 0
    s_nop 0
    buffer_load_dwordx4 v137, s[8:11], 0 offen offset:256 lds
    s_add_u32 m0, s30, 83712
    s_nop 0
    s_nop 0
    buffer_load_dwordx4 v142, s[12:15], 0 offen offset:256 lds
    s_add_u32 m0, s30, 18176
    s_nop 0
    s_nop 0
    buffer_load_dwordx4 v138, s[8:11], 0 offen offset:256 lds
    s_add_u32 m0, s30, 84736
    s_nop 0
    s_nop 0
    buffer_load_dwordx4 v143, s[12:15], 0 offen offset:256 lds
    s_add_u32 m0, s30, 19200
    s_nop 0
    s_nop 0
    buffer_load_dwordx4 v139, s[8:11], 0 offen offset:256 lds
    s_mov_b32 s60, s48
    s_mov_b32 s61, s49
    s_mov_b32 s62, 0x1c0000
    s_mov_b32 s63, 0x00020000
    s_cmp_lt_u32 s2, 224
    s_cselect_b32 s7, 1, 0
    s_cmp_eq_u32 s3, 0
    s_cselect_b32 s94, s7, 0
    s_cmp_eq_u32 s94, 0
    s_cselect_b32 s62, 0, s62
    v_and_b32 v6, 7, v1
    v_bfe_u32 v7, v1, 4, 1
    v_lshlrev_b32 v7, 1, v7
    v_xor_b32 v6, v6, v7
    s_lshr_b32 s28, s2, 3
    s_and_b32 s29, s2, 7
    v_lshrrev_b32 v5, 3, v1
    s_lshl_b32 s7, s4, 4
    v_add_u32 v5, s7, v5
    s_lshl_b32 s7, s28, 6
    v_add_u32 v4, s7, v5
    v_lshlrev_b32 v4, 10, v4
    s_lshl_b32 s7, s29, 7
    v_add_u32 v4, s7, v4
    v_lshl_add_u32 v172, v6, 4, v4
    v_xor_b32_e64 v173, 64, v172
    v_add_u32 v173, 8192, v173
    s_lshl_b32 s31, s4, 11
    s_add_u32 m0, s31, 131072
    s_nop 0
    buffer_load_dwordx4 v172, s[60:63], 0 offen lds
    s_add_u32 m0, s31, 132096
    s_nop 0
    s_nop 0
    buffer_load_dwordx4 v173, s[60:63], 0 offen lds
    s_cmp_lt_u32 s2, 224
    s_cbranch_scc1 ka_nopf
    s_cmp_lg_u32 s3, 0
    s_cbranch_scc1 ka_nopf
    s_getpc_b64 s[56:57]
ka_pc:
    s_add_u32 s56, s56, ks0_kernel-ka_pc
    s_addc_u32 s57, s57, 0
    s_mov_b32 s58, text_end-ks0_kernel
    s_mov_b32 s59, 0x00020000
    s_mul_i32 s7, s4, 5120
    v_lshl_add_u32 v4, v1, 4, s7
    s_nop 0
    buffer_load_dwordx4 v[204:207], v4, s[56:59], 0 offen offset:0
    buffer_load_dwordx4 v[204:207], v4, s[56:59], 0 offen offset:1024
    buffer_load_dwordx4 v[204:207], v4, s[56:59], 0 offen offset:2048
    buffer_load_dwordx4 v[204:207], v4, s[56:59], 0 offen offset:3072
    v_add_u32 v4, 4096, v4
    buffer_load_dwordx4 v[204:207], v4, s[56:59], 0 offen
ka_nopf:
    s_mov_b32 s24, s54
    s_mov_b32 s25, s55
    s_mov_b32 s26, 0x200000
    s_mov_b32 s27, 0x00020000
    s_lshl_b32 s7, s4, 4
    v_add_u32 v4, s7, v2
    v_lshlrev_b32 v5, 8, v3
    v_add_u32 v5, s5, v5
    v_mul_lo_u32 v5, v5, v4
    v_lshlrev_b32 v6, 5, v4
    v_and_b32 v7, 1, v4
    v_mov_b32 v8, 0x80008000
    v_mul_lo_u32 v7, v7, v8
    v_and_b32 v9, 0x7ff, v5
    v_cvt_f32_u32_e64 v9, v9
    v_mul_f32 v9, 0x3a000000, v9
    v_cos_f32 v10, v9
    v_sin_f32 v18, v9
    v_add_u32_e64 v5, v5, v6
    v_and_b32 v9, 0x7ff, v5
    v_cvt_f32_u32_e64 v9, v9
    v_mul_f32 v9, 0x3a000000, v9
    v_cos_f32 v11, v9
    v_sin_f32 v19, v9
    v_add_u32_e64 v5, v5, v6
    v_and_b32 v9, 0x7ff, v5
    v_cvt_f32_u32_e64 v9, v9
    v_mul_f32 v9, 0x3a000000, v9
    v_cos_f32 v12, v9
    v_sin_f32 v20, v9
    v_add_u32_e64 v5, v5, v6
    v_and_b32 v9, 0x7ff, v5
    v_cvt_f32_u32_e64 v9, v9
    v_mul_f32 v9, 0x3a000000, v9
    v_cos_f32 v13, v9
    v_sin_f32 v21, v9
    v_add_u32_e64 v5, v5, v6
    v_and_b32 v9, 0x7ff, v5
    v_cvt_f32_u32_e64 v9, v9
    v_mul_f32 v9, 0x3a000000, v9
    v_cos_f32 v14, v9
    v_sin_f32 v22, v9
    v_add_u32_e64 v5, v5, v6
    v_and_b32 v9, 0x7ff, v5
    v_cvt_f32_u32_e64 v9, v9
    v_mul_f32 v9, 0x3a000000, v9
    v_cos_f32 v15, v9
    v_sin_f32 v23, v9
    v_add_u32_e64 v5, v5, v6
    v_and_b32 v9, 0x7ff, v5
    v_cvt_f32_u32_e64 v9, v9
    v_mul_f32 v9, 0x3a000000, v9
    v_cos_f32 v16, v9
    v_sin_f32 v24, v9
    v_add_u32_e64 v5, v5, v6
    v_and_b32 v9, 0x7ff, v5
    v_cvt_f32_u32_e64 v9, v9
    v_mul_f32 v9, 0x3a000000, v9
    v_cos_f32 v17, v9
    v_sin_f32 v25, v9
    v_cvt_pk_bf16_f32 v180, v10, v11
    v_cvt_pk_bf16_f32 v196, v18, v19
    v_xor_b32 v184, v7, v180
    v_xor_b32 v200, v7, v196
    v_xor_b32 v188, v8, v196
    v_xor_b32 v192, v8, v200
    v_cvt_pk_bf16_f32 v181, v12, v13
    v_cvt_pk_bf16_f32 v197, v20, v21
    v_xor_b32 v185, v7, v181
    v_xor_b32 v201, v7, v197
    v_xor_b32 v189, v8, v197
    v_xor_b32 v193, v8, v201
    v_cvt_pk_bf16_f32 v182, v14, v15
    v_cvt_pk_bf16_f32 v198, v22, v23
    v_xor_b32 v186, v7, v182
    v_xor_b32 v202, v7, v198
    v_xor_b32 v190, v8, v198
    v_xor_b32 v194, v8, v202
    v_cvt_pk_bf16_f32 v183, v16, v17
    v_cvt_pk_bf16_f32 v199, v24, v25
    v_xor_b32 v187, v7, v183
    v_xor_b32 v203, v7, v199
    v_xor_b32 v191, v8, v199
    v_xor_b32 v195, v8, v203
    v_add_u32 v4, 0, v3
    v_xor_b32 v4, v4, v2
    v_lshlrev_b32_e64 v4, 4, v4
    v_lshl_add_u32 v146, v2, 8, v4
    v_add_u32 v150, s30, v146
    v_add_u32 v4, 4, v3
    v_xor_b32 v4, v4, v2
    v_lshlrev_b32 v4, 4, v4
    v_lshl_add_u32 v147, v2, 8, v4
    v_add_u32 v151, s30, v147
    v_add_u32 v4, 8, v3
    v_xor_b32 v4, v4, v2
    v_lshlrev_b32 v4, 4, v4
    v_lshl_add_u32 v148, v2, 8, v4
    v_add_u32 v152, s30, v148
    v_add_u32 v4, 12, v3
    v_xor_b32 v4, v4, v2
    v_lshlrev_b32 v4, 4, v4
    v_lshl_add_u32 v149, v2, 8, v4
    v_add_u32 v153, s30, v149
    s_add_u32 s7, s4, 0
    s_and_b32 s7, s7, 3
    s_lshl_b32 s7, s7, 12
    s_add_u32 s56, s7, 65536
    s_add_u32 s7, s4, 1
    s_and_b32 s7, s7, 3
    s_lshl_b32 s7, s7, 12
    s_add_u32 s57, s7, 65536
    s_add_u32 s7, s4, 2
    s_and_b32 s7, s7, 3
    s_lshl_b32 s7, s7, 12
    s_add_u32 s58, s7, 65536
    s_add_u32 s7, s4, 3
    s_and_b32 s7, s7, 3
    s_lshl_b32 s7, s7, 12
    s_add_u32 s59, s7, 65536
    v_add_u32 v156, s56, v146
    v_add_u32 v157, s57, v146
    v_add_u32 v158, s58, v146
    v_add_u32 v159, s59, v146
    v_add_u32 v160, s56, v147
    v_add_u32 v161, s57, v147
    v_add_u32 v162, s58, v147
    v_add_u32 v163, s59, v147
    v_add_u32 v164, s56, v148
    v_add_u32 v165, s57, v148
    v_add_u32 v166, s58, v148
    v_add_u32 v167, s59, v148
    v_add_u32 v168, s56, v149
    v_add_u32 v169, s57, v149
    v_add_u32 v170, s58, v149
    v_add_u32_e64 v171, s59, v149
    v_mov_b32 v132, 0x3f803f80
    v_mov_b32 v133, 0x3f803f80
    v_mov_b32 v134, 0x3f803f80
    v_mov_b32 v135, 0x3f803f80
    s_waitcnt vmcnt(10)
    s_barrier
    s_add_u32 m0, s30, 97792
    s_nop 0
    s_nop 0
    buffer_load_dwordx4 v140, s[12:15], 0 offen offset:512 lds
    s_add_u32 m0, s30, 32256
    s_nop 0
    s_nop 0
    buffer_load_dwordx4 v136, s[8:11], 0 offen offset:512 lds
    s_add_u32 m0, s30, 98816
    s_nop 0
    s_nop 0
    buffer_load_dwordx4 v141, s[12:15], 0 offen offset:512 lds
    s_add_u32 m0, s30, 33280
    s_nop 0
    s_nop 0
    buffer_load_dwordx4 v137, s[8:11], 0 offen offset:512 lds
    s_add_u32 m0, s30, 99840
    s_nop 0
    s_nop 0
    buffer_load_dwordx4 v142, s[12:15], 0 offen offset:512 lds
    s_add_u32 m0, s30, 34304
    s_nop 0
    s_nop 0
    buffer_load_dwordx4 v138, s[8:11], 0 offen offset:512 lds
    s_add_u32 m0, s30, 100864
    s_nop 0
    s_nop 0
    buffer_load_dwordx4 v143, s[12:15], 0 offen offset:512 lds
    s_add_u32 m0, s30, 35328
    s_nop 0
    s_nop 0
    buffer_load_dwordx4 v139, s[8:11], 0 offen offset:512 lds
    ds_read_b128 v[64:67], v150 offset:0
    ds_read_b128 v[32:35], v156 offset:0
    ds_read_b128 v[36:39], v157 offset:0
    ds_read_b128 v[40:43], v158 offset:0
    ds_read_b128 v[44:47], v159 offset:0
    ds_read_b128 v[68:71], v151 offset:0
    ds_read_b128 v[48:51], v160 offset:0
    ds_read_b128 v[52:55], v161 offset:0
    ds_read_b128 v[56:59], v162 offset:0
    ds_read_b128 v[60:63], v163 offset:0
    s_waitcnt lgkmcnt(5)
    s_nop 0
    v_mfma_f32_16x16x32_bf16 v[8:11], v[32:35], v[64:67], 0
    v_mfma_f32_16x16x32_bf16 v[12:15], v[36:39], v[64:67], 0
    v_mfma_f32_16x16x32_bf16 v[16:19], v[40:43], v[64:67], 0
    v_mfma_f32_16x16x32_bf16 v[20:23], v[44:47], v[64:67], 0
    v_mfma_f32_16x16x32_bf16 v[24:27], v[132:135], v[64:67], 0
    v_mfma_f32_16x16x32_bf16 v[28:31], v[64:67], v[64:67], 0
    v_mfma_f32_16x16x32_bf16 v[128:131], v[32:35], v[132:135], 0
    ds_read_b128 v[64:67], v152 offset:0
    ds_read_b128 v[32:35], v164 offset:0
    ds_read_b128 v[36:39], v165 offset:0
    ds_read_b128 v[40:43], v166 offset:0
    ds_read_b128 v[44:47], v167 offset:0
    s_waitcnt lgkmcnt(5)
    s_nop 0
    v_mfma_f32_16x16x32_bf16 v[8:11], v[48:51], v[68:71], v[8:11]
    v_mfma_f32_16x16x32_bf16 v[12:15], v[52:55], v[68:71], v[12:15]
    v_mfma_f32_16x16x32_bf16 v[16:19], v[56:59], v[68:71], v[16:19]
    v_mfma_f32_16x16x32_bf16 v[20:23], v[60:63], v[68:71], v[20:23]
    v_mfma_f32_16x16x32_bf16 v[24:27], v[132:135], v[68:71], v[24:27]
    v_mfma_f32_16x16x32_bf16 v[28:31], v[68:71], v[68:71], v[28:31]
    v_mfma_f32_16x16x32_bf16 v[128:131], v[48:51], v[132:135], v[128:131]
    ds_read_b128 v[68:71], v153 offset:0
    ds_read_b128 v[48:51], v168 offset:0
    ds_read_b128 v[52:55], v169 offset:0
    ds_read_b128 v[56:59], v170 offset:0
    ds_read_b128 v[60:63], v171 offset:0
    s_waitcnt lgkmcnt(5)
    s_nop 0
    v_mfma_f32_16x16x32_bf16 v[8:11], v[32:35], v[64:67], v[8:11]
    v_mfma_f32_16x16x32_bf16 v[12:15], v[36:39], v[64:67], v[12:15]
    v_mfma_f32_16x16x32_bf16 v[16:19], v[40:43], v[64:67], v[16:19]
    v_mfma_f32_16x16x32_bf16 v[20:23], v[44:47], v[64:67], v[20:23]
    v_mfma_f32_16x16x32_bf16 v[24:27], v[132:135], v[64:67], v[24:27]
    v_mfma_f32_16x16x32_bf16 v[28:31], v[64:67], v[64:67], v[28:31]
    v_mfma_f32_16x16x32_bf16 v[128:131], v[32:35], v[132:135], v[128:131]
    s_waitcnt lgkmcnt(0)
    s_nop 0
    v_mfma_f32_16x16x32_bf16 v[8:11], v[48:51], v[68:71], v[8:11]
    v_mfma_f32_16x16x32_bf16 v[12:15], v[52:55], v[68:71], v[12:15]
    v_mfma_f32_16x16x32_bf16 v[16:19], v[56:59], v[68:71], v[16:19]
    v_mfma_f32_16x16x32_bf16 v[20:23], v[60:63], v[68:71], v[20:23]
    v_mfma_f32_16x16x32_bf16 v[24:27], v[132:135], v[68:71], v[24:27]
    v_mfma_f32_16x16x32_bf16 v[28:31], v[68:71], v[68:71], v[28:31]
    v_mfma_f32_16x16x32_bf16 v[128:131], v[48:51], v[132:135], v[128:131]
    s_waitcnt vmcnt(8)
    s_barrier
    s_add_u32 m0, s30, 113920
    s_nop 0
    s_nop 0
    buffer_load_dwordx4 v140, s[12:15], 0 offen offset:768 lds
    s_add_u32 m0, s30, 48384
    s_nop 0
    s_nop 0
    buffer_load_dwordx4 v136, s[8:11], 0 offen offset:768 lds
    s_add_u32 m0, s30, 114944
    s_nop 0
    s_nop 0
    buffer_load_dwordx4 v141, s[12:15], 0 offen offset:768 lds
    s_add_u32 m0, s30, 49408
    s_nop 0
    s_nop 0
    buffer_load_dwordx4 v137, s[8:11], 0 offen offset:768 lds
    s_add_u32 m0, s30, 115968
    s_nop 0
    s_nop 0
    buffer_load_dwordx4 v142, s[12:15], 0 offen offset:768 lds
    s_add_u32 m0, s30, 50432
    s_nop 0
    s_nop 0
    buffer_load_dwordx4 v138, s[8:11], 0 offen offset:768 lds
    s_add_u32 m0, s30, 116992
    s_nop 0
    s_nop 0
    buffer_load_dwordx4 v143, s[12:15], 0 offen offset:768 lds
    s_add_u32 m0, s30, 51456
    s_nop 0
    s_nop 0
    buffer_load_dwordx4 v139, s[8:11], 0 offen offset:768 lds
    s_cmp_eq_u32 s94, 0
    s_cbranch_scc1 ka_nowd
    s_add_u32 s60, s54, 0x1400000
    s_addc_u32 s61, s55, 0
    s_mov_b32 s62, 0x1c0000
    s_mov_b32 s63, 0x00020000
    v_lshrrev_b32 v4, 2, v2
    v_and_b32 v5, 3, v2
    v_lshrrev_b32 v6, 5, v1
    v_bfe_u32 v7, v1, 4, 1
    v_lshrrev_b32 v172, 1, v4
    s_lshl_b32 s7, s4, 4
    v_lshl_add_u32 v173, v6, 2, v4
    v_add_u32 v173, s7, v173
    v_lshlrev_b32 v173, 7, v173
    v_lshl_add_u32 v173, v5, 3, v173
    v_add_u32 v173, 131072, v173
    v_lshl_or_b32 v4, 0, 1, v172
    v_or_b32 v5, 0, v7
    v_xor_b32 v4, v4, v5
    v_lshl_add_u32 v4, v4, 5, v173
    ds_read_b64_tr_b16 v[204:205], v4 offset:0
    v_lshl_or_b32 v4, 1, 1, v172
    v_or_b32 v5, 0, v7
    v_xor_b32 v4, v4, v5
    v_lshl_add_u32 v4, v4, 5, v173
    ds_read_b64_tr_b16 v[206:207], v4 offset:1024
    v_lshl_or_b32 v4, 0, 1, v172
    v_or_b32 v5, 2, v7
    v_xor_b32 v4, v4, v5
    v_lshl_add_u32 v4, v4, 5, v173
    ds_read_b64_tr_b16 v[208:209], v4 offset:0
    v_lshl_or_b32 v4, 1, 1, v172
    v_or_b32 v5, 2, v7
    v_xor_b32 v4, v4, v5
    v_lshl_add_u32 v4, v4, 5, v173
    ds_read_b64_tr_b16 v[210:211], v4 offset:1024
    s_lshr_b32 s28, s2, 3
    s_and_b32 s29, s2, 7
    s_mul_i32 s7, s29, 224
    s_lshl_b32 s28, s28, 2
    s_add_u32 s7, s7, s28
    s_add_u32 s7, s7, s4
    s_lshl_b32 s7, s7, 10
    v_lshl_add_u32 v174, v1, 4, s7
    s_waitcnt lgkmcnt(0)
    s_mov_b32 s7, 0
    buffer_store_dwordx4 v[204:207], v174, s[60:63], s7 offen sc1
    s_mov_b32 s7, 114688
    buffer_store_dwordx4 v[208:211], v174, s[60:63], s7 offen sc1
ka_nowd:
    ds_read_b128 v[64:67], v150 offset:16384
    ds_read_b128 v[32:35], v156 offset:16384
    ds_read_b128 v[36:39], v157 offset:16384
    ds_read_b128 v[40:43], v158 offset:16384
    ds_read_b128 v[44:47], v159 offset:16384
    ds_read_b128 v[68:71], v151 offset:16384
    ds_read_b128 v[48:51], v160 offset:16384
    ds_read_b128 v[52:55], v161 offset:16384
    ds_read_b128 v[56:59], v162 offset:16384
    ds_read_b128 v[60:63], v163 offset:16384
    s_waitcnt lgkmcnt(5)
    s_nop 0
    v_mfma_f32_16x16x32_bf16 v[8:11], v[32:35], v[64:67], v[8:11]
    v_mfma_f32_16x16x32_bf16 v[12:15], v[36:39], v[64:67], v[12:15]
    v_mfma_f32_16x16x32_bf16 v[16:19], v[40:43], v[64:67], v[16:19]
    v_mfma_f32_16x16x32_bf16 v[20:23], v[44:47], v[64:67], v[20:23]
    v_mfma_f32_16x16x32_bf16 v[24:27], v[132:135], v[64:67], v[24:27]
    v_mfma_f32_16x16x32_bf16 v[28:31], v[64:67], v[64:67], v[28:31]
    v_mfma_f32_16x16x32_bf16 v[128:131], v[32:35], v[132:135], v[128:131]
    ds_read_b128 v[64:67], v152 offset:16384
    ds_read_b128 v[32:35], v164 offset:16384
    ds_read_b128 v[36:39], v165 offset:16384
    ds_read_b128 v[40:43], v166 offset:16384
    ds_read_b128 v[44:47], v167 offset:16384
    s_waitcnt lgkmcnt(5)
    s_nop 0
    v_mfma_f32_16x16x32_bf16 v[8:11], v[48:51], v[68:71], v[8:11]
    v_mfma_f32_16x16x32_bf16 v[12:15], v[52:55], v[68:71], v[12:15]
    v_mfma_f32_16x16x32_bf16 v[16:19], v[56:59], v[68:71], v[16:19]
    v_mfma_f32_16x16x32_bf16 v[20:23], v[60:63], v[68:71], v[20:23]
    v_mfma_f32_16x16x32_bf16 v[24:27], v[132:135], v[68:71], v[24:27]
    v_mfma_f32_16x16x32_bf16 v[28:31], v[68:71], v[68:71], v[28:31]
    v_mfma_f32_16x16x32_bf16 v[128:131], v[48:51], v[132:135], v[128:131]
    ds_read_b128 v[68:71], v153 offset:16384
    ds_read_b128 v[48:51], v168 offset:16384
    ds_read_b128 v[52:55], v169 offset:16384
    ds_read_b128 v[56:59], v170 offset:16384
    ds_read_b128 v[60:63], v171 offset:16384
    s_waitcnt lgkmcnt(5)
    s_nop 0
    v_mfma_f32_16x16x32_bf16 v[8:11], v[32:35], v[64:67], v[8:11]
    v_mfma_f32_16x16x32_bf16 v[12:15], v[36:39], v[64:67], v[12:15]
    v_mfma_f32_16x16x32_bf16 v[16:19], v[40:43], v[64:67], v[16:19]
    v_mfma_f32_16x16x32_bf16 v[20:23], v[44:47], v[64:67], v[20:23]
    v_mfma_f32_16x16x32_bf16 v[24:27], v[132:135], v[64:67], v[24:27]
    v_mfma_f32_16x16x32_bf16 v[28:31], v[64:67], v[64:67], v[28:31]
    v_mfma_f32_16x16x32_bf16 v[128:131], v[32:35], v[132:135], v[128:131]
    s_waitcnt lgkmcnt(0)
    s_nop 0
    v_mfma_f32_16x16x32_bf16 v[8:11], v[48:51], v[68:71], v[8:11]
    v_mfma_f32_16x16x32_bf16 v[12:15], v[52:55], v[68:71], v[12:15]
    v_mfma_f32_16x16x32_bf16 v[16:19], v[56:59], v[68:71], v[16:19]
    v_mfma_f32_16x16x32_bf16 v[20:23], v[60:63], v[68:71], v[20:23]
    v_mfma_f32_16x16x32_bf16 v[24:27], v[132:135], v[68:71], v[24:27]
    v_mfma_f32_16x16x32_bf16 v[28:31], v[68:71], v[68:71], v[28:31]
    v_mfma_f32_16x16x32_bf16 v[128:131], v[48:51], v[132:135], v[128:131]
    s_waitcnt vmcnt(8)
    s_barrier
    ds_read_b128 v[64:67], v150 offset:32768
    ds_read_b128 v[32:35], v156 offset:32768
    ds_read_b128 v[36:39], v157 offset:32768
    ds_read_b128 v[40:43], v158 offset:32768
    ds_read_b128 v[44:47], v159 offset:32768
    ds_read_b128 v[68:71], v151 offset:32768
    ds_read_b128 v[48:51], v160 offset:32768
    ds_read_b128 v[52:55], v161 offset:32768
    ds_read_b128 v[56:59], v162 offset:32768
    ds_read_b128 v[60:63], v163 offset:32768
    s_waitcnt lgkmcnt(5)
    s_nop 0
    v_mfma_f32_16x16x32_bf16 v[8:11], v[32:35], v[64:67], v[8:11]
    v_mfma_f32_16x16x32_bf16 v[12:15], v[36:39], v[64:67], v[12:15]
    v_mfma_f32_16x16x32_bf16 v[16:19], v[40:43], v[64:67], v[16:19]
    v_mfma_f32_16x16x32_bf16 v[20:23], v[44:47], v[64:67], v[20:23]
    v_mfma_f32_16x16x32_bf16 v[24:27], v[132:135], v[64:67], v[24:27]
    v_mfma_f32_16x16x32_bf16 v[28:31], v[64:67], v[64:67], v[28:31]
    v_mfma_f32_16x16x32_bf16 v[128:131], v[32:35], v[132:135], v[128:131]
    ds_read_b128 v[64:67], v152 offset:32768
    ds_read_b128 v[32:35], v164 offset:32768
    ds_read_b128 v[36:39], v165 offset:32768
    ds_read_b128 v[40:43], v166 offset:32768
    ds_read_b128 v[44:47], v167 offset:32768
    s_waitcnt lgkmcnt(5)
    s_nop 0
    v_mfma_f32_16x16x32_bf16 v[8:11], v[48:51], v[68:71], v[8:11]
    v_mfma_f32_16x16x32_bf16 v[12:15], v[52:55], v[68:71], v[12:15]
    v_mfma_f32_16x16x32_bf16 v[16:19], v[56:59], v[68:71], v[16:19]
    v_mfma_f32_16x16x32_bf16 v[20:23], v[60:63], v[68:71], v[20:23]
    v_mfma_f32_16x16x32_bf16 v[24:27], v[132:135], v[68:71], v[24:27]
    v_mfma_f32_16x16x32_bf16 v[28:31], v[68:71], v[68:71], v[28:31]
    v_mfma_f32_16x16x32_bf16 v[128:131], v[48:51], v[132:135], v[128:131]
    ds_read_b128 v[68:71], v153 offset:32768
    ds_read_b128 v[48:51], v168 offset:32768
    ds_read_b128 v[52:55], v169 offset:32768
    ds_read_b128 v[56:59], v170 offset:32768
    ds_read_b128 v[60:63], v171 offset:32768
    s_waitcnt lgkmcnt(5)
    s_nop 0
    v_mfma_f32_16x16x32_bf16 v[8:11], v[32:35], v[64:67], v[8:11]
    v_mfma_f32_16x16x32_bf16 v[12:15], v[36:39], v[64:67], v[12:15]
    v_mfma_f32_16x16x32_bf16 v[16:19], v[40:43], v[64:67], v[16:19]
    v_mfma_f32_16x16x32_bf16 v[20:23], v[44:47], v[64:67], v[20:23]
    v_mfma_f32_16x16x32_bf16 v[24:27], v[132:135], v[64:67], v[24:27]
    v_mfma_f32_16x16x32_bf16 v[28:31], v[64:67], v[64:67], v[28:31]
    v_mfma_f32_16x16x32_bf16 v[128:131], v[32:35], v[132:135], v[128:131]
    s_waitcnt lgkmcnt(0)
    s_nop 0
    v_mfma_f32_16x16x32_bf16 v[8:11], v[48:51], v[68:71], v[8:11]
    v_mfma_f32_16x16x32_bf16 v[12:15], v[52:55], v[68:71], v[12:15]
    v_mfma_f32_16x16x32_bf16 v[16:19], v[56:59], v[68:71], v[16:19]
    v_mfma_f32_16x16x32_bf16 v[20:23], v[60:63], v[68:71], v[20:23]
    v_mfma_f32_16x16x32_bf16 v[24:27], v[132:135], v[68:71], v[24:27]
    v_mfma_f32_16x16x32_bf16 v[28:31], v[68:71], v[68:71], v[28:31]
    v_mfma_f32_16x16x32_bf16 v[128:131], v[48:51], v[132:135], v[128:131]
    s_waitcnt vmcnt(0)
    s_barrier
    ds_read_b128 v[64:67], v150 offset:49152
    ds_read_b128 v[32:35], v156 offset:49152
    ds_read_b128 v[36:39], v157 offset:49152
    ds_read_b128 v[40:43], v158 offset:49152
    ds_read_b128 v[44:47], v159 offset:49152
    ds_read_b128 v[68:71], v151 offset:49152
    ds_read_b128 v[48:51], v160 offset:49152
    ds_read_b128 v[52:55], v161 offset:49152
    ds_read_b128 v[56:59], v162 offset:49152
    ds_read_b128 v[60:63], v163 offset:49152
    s_waitcnt lgkmcnt(5)
    s_nop 0
    v_mfma_f32_16x16x32_bf16 v[8:11], v[32:35], v[64:67], v[8:11]
    v_mfma_f32_16x16x32_bf16 v[12:15], v[36:39], v[64:67], v[12:15]
    v_mfma_f32_16x16x32_bf16 v[16:19], v[40:43], v[64:67], v[16:19]
    v_mfma_f32_16x16x32_bf16 v[20:23], v[44:47], v[64:67], v[20:23]
    v_mfma_f32_16x16x32_bf16 v[24:27], v[132:135], v[64:67], v[24:27]
    v_mfma_f32_16x16x32_bf16 v[28:31], v[64:67], v[64:67], v[28:31]
    v_mfma_f32_16x16x32_bf16 v[128:131], v[32:35], v[132:135], v[128:131]
    ds_read_b128 v[64:67], v152 offset:49152
    ds_read_b128 v[32:35], v164 offset:49152
    ds_read_b128 v[36:39], v165 offset:49152
    ds_read_b128 v[40:43], v166 offset:49152
    ds_read_b128 v[44:47], v167 offset:49152
    s_waitcnt lgkmcnt(5)
    s_nop 0
    v_mfma_f32_16x16x32_bf16 v[8:11], v[48:51], v[68:71], v[8:11]
    v_mfma_f32_16x16x32_bf16 v[12:15], v[52:55], v[68:71], v[12:15]
    v_mfma_f32_16x16x32_bf16 v[16:19], v[56:59], v[68:71], v[16:19]
    v_mfma_f32_16x16x32_bf16 v[20:23], v[60:63], v[68:71], v[20:23]
    v_mfma_f32_16x16x32_bf16 v[24:27], v[132:135], v[68:71], v[24:27]
    v_mfma_f32_16x16x32_bf16 v[28:31], v[68:71], v[68:71], v[28:31]
    v_mfma_f32_16x16x32_bf16 v[128:131], v[48:51], v[132:135], v[128:131]
    ds_read_b128 v[68:71], v153 offset:49152
    ds_read_b128 v[48:51], v168 offset:49152
    ds_read_b128 v[52:55], v169 offset:49152
    ds_read_b128 v[56:59], v170 offset:49152
    ds_read_b128 v[60:63], v171 offset:49152
    s_waitcnt lgkmcnt(5)
    s_nop 0
    v_mfma_f32_16x16x32_bf16 v[8:11], v[32:35], v[64:67], v[8:11]
    v_mfma_f32_16x16x32_bf16 v[12:15], v[36:39], v[64:67], v[12:15]
    v_mfma_f32_16x16x32_bf16 v[16:19], v[40:43], v[64:67], v[16:19]
    v_mfma_f32_16x16x32_bf16 v[20:23], v[44:47], v[64:67], v[20:23]
    v_mfma_f32_16x16x32_bf16 v[24:27], v[132:135], v[64:67], v[24:27]
    v_mfma_f32_16x16x32_bf16 v[28:31], v[64:67], v[64:67], v[28:31]
    v_mfma_f32_16x16x32_bf16 v[128:131], v[32:35], v[132:135], v[128:131]
    s_waitcnt lgkmcnt(0)
    s_nop 0
    v_mfma_f32_16x16x32_bf16 v[8:11], v[48:51], v[68:71], v[8:11]
    v_mfma_f32_16x16x32_bf16 v[12:15], v[52:55], v[68:71], v[12:15]
    v_mfma_f32_16x16x32_bf16 v[16:19], v[56:59], v[68:71], v[16:19]
    v_mfma_f32_16x16x32_bf16 v[20:23], v[60:63], v[68:71], v[20:23]
    v_mfma_f32_16x16x32_bf16 v[24:27], v[132:135], v[68:71], v[24:27]
    v_mfma_f32_16x16x32_bf16 v[28:31], v[68:71], v[68:71], v[28:31]
    v_mfma_f32_16x16x32_bf16 v[128:131], v[48:51], v[132:135], v[128:131]
    s_nop 7
    s_nop 3
    s_lshl_b32 s7, s4, 6
    v_lshl_add_u32 v4, v3, 4, s7
    v_cmp_eq_u32 vcc, 0, v2
    s_and_saveexec_b64 s[56:57], vcc
    s_nop 0
    ds_write_b128 v4, v[128:131]
    s_mov_b64 exec, s[56:57]
    v_and_b32 v5, 3, v2
    v_cmp_eq_u32 vcc, 1, v5
    v_cndmask_b32 v6, v28, v29, vcc
    v_cmp_eq_u32 vcc, 2, v5
    v_cndmask_b32 v6, v6, v30, vcc
    v_cmp_eq_u32 vcc, 3, v5
    v_cndmask_b32 v6, v6, v31, vcc
    v_lshrrev_b32_e64 v5, 2, v2
    v_lshl_add_u32 v5, v5, 4, v2
    v_lshlrev_b32_e64 v5, 2, v5
    ds_bpermute_b32 v6, v5, v6
    v_mul_f32 v7, 0x3b000000, v24
    s_waitcnt lgkmcnt(0)
    s_barrier
    v_mul_f32 v6, 0x3b000000, v6
    v_fma_f32 v6, -v7, v7, v6
    v_add_f32 v6, 0x3727c5ac, v6
    v_rsq_f32 v6, v6
    s_add_u32 s7, s4, 0
    s_and_b32 s7, s7, 3
    s_lshl_b32 s28, s7, 6
    v_lshl_add_u32 v4, v3, 4, s28
    ds_read_b128 v[32:35], v4
    v_bfe_u32 v144, v2, 1, 1
    v_bfe_u32 v145, v2, 3, 1
    v_lshl_or_b32 v144, v145, 1, v144
    s_lshl_b32 s29, s4, 4
    v_add_u32 v145, s29, v2
    v_lshlrev_b32_e64 v145, 7, v145
    v_lshl_add_u32 v145, v3, 3, v145
    v_add_u32 v145, 1024, v145
    v_xor_b32_e64 v5, s7, v144
    v_lshl_add_u32 v146, v5, 5, v145
    s_add_u32 s7, s4, 1
    s_and_b32 s7, s7, 3
    s_lshl_b32 s28, s7, 6
    v_lshl_add_u32 v4, v3, 4, s28
    s_nop 0
    ds_read_b128 v[36:39], v4
    v_xor_b32_e64 v5, s7, v144
    v_lshl_add_u32 v147, v5, 5, v145
    s_add_u32 s7, s4, 2
    s_and_b32 s7, s7, 3
    s_lshl_b32 s28, s7, 6
    v_lshl_add_u32 v4, v3, 4, s28
    s_nop 0
    ds_read_b128 v[40:43], v4
    v_xor_b32_e64 v5, s7, v144
    v_lshl_add_u32 v148, v5, 5, v145
    s_add_u32 s7, s4, 3
    s_and_b32 s7, s7, 3
    s_lshl_b32 s28, s7, 6
    v_lshl_add_u32 v4, v3, 4, s28
    s_nop 0
    ds_read_b128 v[44:47], v4
    v_xor_b32_e64 v5, s7, v144
    v_lshl_add_u32 v149, v5, 5, v145
    v_sub_f32 v7, 0, v7
    s_waitcnt lgkmcnt(0)
    v_fma_f32 v8, v7, v32, v8
    v_mul_f32_e64 v8, v6, v8
    v_fma_f32 v9, v7, v33, v9
    v_mul_f32_e64 v9, v6, v9
    v_fma_f32 v10, v7, v34, v10
    v_mul_f32_e64 v10, v6, v10
    v_fma_f32 v11, v7, v35, v11
    v_mul_f32_e64 v11, v6, v11
    v_cvt_pk_bf16_f32 v8, v8, v9
    v_cvt_pk_bf16_f32 v9, v10, v11
    ds_write_b64 v146, v[8:9]
    v_fma_f32 v12, v7, v36, v12
    v_mul_f32_e64 v12, v6, v12
    v_fma_f32 v13, v7, v37, v13
    v_mul_f32_e64 v13, v6, v13
    v_fma_f32 v14, v7, v38, v14
    v_mul_f32_e64 v14, v6, v14
    v_fma_f32 v15, v7, v39, v15
    v_mul_f32_e64 v15, v6, v15
    v_cvt_pk_bf16_f32 v12, v12, v13
    v_cvt_pk_bf16_f32 v13, v14, v15
    ds_write_b64 v147, v[12:13]
    v_fma_f32 v16, v7, v40, v16
    v_mul_f32_e64 v16, v6, v16
    v_fma_f32 v17, v7, v41, v17
    v_mul_f32_e64 v17, v6, v17
    v_fma_f32 v18, v7, v42, v18
    v_mul_f32_e64 v18, v6, v18
    v_fma_f32 v19, v7, v43, v19
    v_mul_f32_e64 v19, v6, v19
    v_cvt_pk_bf16_f32 v16, v16, v17
    v_cvt_pk_bf16_f32 v17, v18, v19
    ds_write_b64 v148, v[16:17]
    v_fma_f32 v20, v7, v44, v20
    v_mul_f32_e64 v20, v6, v20
    v_fma_f32 v21, v7, v45, v21
    v_mul_f32_e64 v21, v6, v21
    v_fma_f32 v22, v7, v46, v22
    v_mul_f32_e64 v22, v6, v22
    v_fma_f32 v23, v7, v47, v23
    v_mul_f32_e64 v23, v6, v23
    v_cvt_pk_bf16_f32 v20, v20, v21
    v_cvt_pk_bf16_f32 v21, v22, v23
    ds_write_b64 v149, v[20:21]
    v_lshrrev_b32 v4, 2, v2
    v_and_b32 v5, 3, v2
    v_lshrrev_b32 v6, 1, v4
    v_and_b32 v7, 1, v3
    v_lshl_or_b32 v6, v7, 1, v6
    v_lshl_add_u32 v7, v3, 3, v4
    v_lshlrev_b32 v7, 7, v7
    v_lshrrev_b32 v150, 1, v5
    v_xor_b32 v150, v150, v6
    v_and_b32 v151, 1, v5
    v_lshlrev_b32 v151, 4, v151
    v_add_u32 v151, v151, v7
    v_add_u32 v151, 1024, v151
    v_lshl_add_u32 v152, v150, 5, v151
    v_xor_b32_e64 v150, 2, v150
    v_lshl_add_u32 v153, v150, 5, v151
    s_waitcnt lgkmcnt(0)
    s_barrier
    ds_read_b64_tr_b16 v[64:65], v152 offset:0
    ds_read_b64_tr_b16 v[66:67], v152 offset:512
    ds_read_b64_tr_b16 v[68:69], v152 offset:4096
    ds_read_b64_tr_b16 v[70:71], v152 offset:4608
    ds_read_b64_tr_b16 v[72:73], v152 offset:8
    ds_read_b64_tr_b16 v[74:75], v152 offset:520
    ds_read_b64_tr_b16 v[76:77], v152 offset:4104
    ds_read_b64_tr_b16 v[78:79], v152 offset:4616
    ds_read_b64_tr_b16 v[80:81], v153 offset:0
    ds_read_b64_tr_b16 v[82:83], v153 offset:512
    ds_read_b64_tr_b16 v[84:85], v153 offset:4096
    ds_read_b64_tr_b16 v[86:87], v153 offset:4608
    ds_read_b64_tr_b16 v[88:89], v153 offset:8
    ds_read_b64_tr_b16 v[90:91], v153 offset:520
    ds_read_b64_tr_b16 v[92:93], v153 offset:4104
    ds_read_b64_tr_b16 v[94:95], v153 offset:4616
    s_waitcnt lgkmcnt(0)
    s_nop 0
    v_mfma_f32_16x16x32_bf16 v[96:99], v[64:67], v[180:183], 0
    v_mfma_f32_16x16x32_bf16 v[96:99], v[80:83], v[196:199], v[96:99]
    v_mfma_f32_16x16x32_bf16 v[96:99], v[68:71], v[184:187], v[96:99]
    v_mfma_f32_16x16x32_bf16 v[96:99], v[84:87], v[200:203], v[96:99]
    v_mfma_f32_16x16x32_bf16 v[104:107], v[80:83], v[180:183], 0
    v_mfma_f32_16x16x32_bf16 v[104:107], v[64:67], v[188:191], v[104:107]
    v_mfma_f32_16x16x32_bf16 v[104:107], v[84:87], v[184:187], v[104:107]
    v_mfma_f32_16x16x32_bf16 v[104:107], v[68:71], v[192:195], v[104:107]
    v_mfma_f32_16x16x32_bf16 v[100:103], v[72:75], v[180:183], 0
    v_mfma_f32_16x16x32_bf16 v[100:103], v[88:91], v[196:199], v[100:103]
    v_mfma_f32_16x16x32_bf16 v[100:103], v[76:79], v[184:187], v[100:103]
    v_mfma_f32_16x16x32_bf16 v[100:103], v[92:95], v[200:203], v[100:103]
    v_mfma_f32_16x16x32_bf16 v[108:111], v[88:91], v[180:183], 0
    v_mfma_f32_16x16x32_bf16 v[108:111], v[72:75], v[188:191], v[108:111]
    v_mfma_f32_16x16x32_bf16 v[108:111], v[92:95], v[184:187], v[108:111]
    v_mfma_f32_16x16x32_bf16 v[108:111], v[76:79], v[192:195], v[108:111]
    s_lshl_b32 s7, s4, 4
    v_add_u32 v4, s7, v2
    v_lshlrev_b32_e64 v4, 15, v4
    v_lshl_add_u32 v4, v3, 4, v4
    s_lshl_b32 s28, s5, 10
    s_lshl_b32 s29, s6, 6
    s_add_u32 s28, s28, s29
    v_add_u32 v4, s28, v4
    s_waitcnt vmcnt(0)
    s_nop 7
    v_cvt_pk_bf16_f32 v96, v96, v97
    v_cvt_pk_bf16_f32 v97, v98, v99
    v_cvt_pk_bf16_f32 v98, v100, v101
    v_cvt_pk_bf16_f32 v99, v102, v103
    buffer_store_dwordx4 v[96:99], v4, s[24:27], 0 offen offset:0 sc1
    v_cvt_pk_bf16_f32 v104, v104, v105
    v_cvt_pk_bf16_f32 v105, v106, v107
    v_cvt_pk_bf16_f32 v106, v108, v109
    v_cvt_pk_bf16_f32 v107, v110, v111
    buffer_store_dwordx4 v[104:107], v4, s[24:27], 0 offen offset:512 sc1
ka_done:
ka_exit:
    s_endpgm
.p2align 8
.globl ks0_kernel
.type ks0_kernel,@function
ks0_kernel:
    s_mov_b32 s3, 0
    s_branch ks_body
.p2align 8
.globl ks1_kernel
.type ks1_kernel,@function
ks1_kernel:
    s_mov_b32 s3, 1
    s_branch ks_body
ks_body:
    s_load_dwordx16 s[32:47], s[0:1], 0
    s_load_dwordx8 s[48:55], s[0:1], 64
    v_and_b32 v1, 63, v0
    v_lshrrev_b32 v4, 6, v0
    v_and_b32_e64 v2, 15, v0
    v_bfe_u32 v3, v0, 4, 2
    v_readfirstlane_b32 s4, v4
    s_cmp_ge_u32 s2, 128
    s_cbranch_scc1 ks_prep
    s_and_b32 s5, s2, 7
    s_lshr_b32 s6, s2, 5
    s_lshl_b32 s6, s6, 3
    s_add_u32 s5, s5, s6
    s_bfe_u32 s6, s2, 0x10003
    s_bfe_u32 s7, s2, 0x10004
    s_sub_u32 s28, 64, s5
    s_cmp_eq_u32 s5, 0
    s_cselect_b32 s28, 32, s28
    s_cmp_eq_u32 s7, 0
    s_cselect_b32 s5, s5, s28
    s_sub_u32 s7, 64, s5
    s_and_b32 s7, s7, 63
    v_lshrrev_b32 v4, 3, v1
    v_lshlrev_b32 v4, 9, v4
    s_lshl_b32 s28, s4, 7
    v_add_u32 v4, s28, v4
    v_and_b32 v5, 7, v1
    v_bfe_u32 v6, v1, 4, 1
    v_lshlrev_b32 v6, 1, v6
    v_xor_b32 v5, v5, v6
    v_lshl_add_u32 v8, v5, 4, v4
    v_xor_b32 v9, 64, v8
    s_lshl_b32 s30, s4, 14
    s_lshl_b32 s28, s6, 4
    v_add_u32 v10, s28, v2
    s_cmp_eq_u32 s5, 0
    s_cselect_b32 s29, 32, 31
    v_sub_u32 v11, s29, v10
    v_and_b32 v11, 31, v11
    v_lshlrev_b32 v14, 6, v10
    v_add_u32 v14, s5, v14
    v_lshlrev_b32_e64 v14, 10, v14
    v_lshl_add_u32 v14, v3, 4, v14
    s_lshl_b32 s28, s4, 8
    v_add_u32 v14, s28, v14
    s_lshl_b32 s28, s5, 15
    s_lshl_b32 s29, s4, 13
    s_add_u32 s28, s28, s29
    s_lshl_b32 s29, s6, 8
    s_add_u32 s28, s28, s29
    v_lshlrev_b32 v15, 9, v3
    v_lshl_add_u32 v15, v2, 4, v15
    v_add_u32 v15, s28, v15
    s_waitcnt lgkmcnt(0)
    s_mov_b32 s12, s54
    s_mov_b32 s13, s55
    s_mov_b32 s14, 0x200000
    s_mov_b32 s15, 0x00020000
    s_lshl_b32 s31, s5, 15
    s_add_u32 m0, s30, 0
    s_add_u32 s29, s31, 0
    s_nop 0
    buffer_load_dwordx4 v8, s[12:15], s29 offen lds
    s_add_u32 m0, s30, 1024
    s_add_u32 s29, s31, 4096
    buffer_load_dwordx4 v9, s[12:15], s29 offen lds
    s_add_u32 m0, s30, 2048
    s_add_u32 s29, s31, 8192
    buffer_load_dwordx4 v8, s[12:15], s29 offen lds
    s_add_u32 m0, s30, 3072
    s_add_u32 s29, s31, 12288
    buffer_load_dwordx4 v9, s[12:15], s29 offen lds
    s_add_u32 m0, s30, 4096
    s_add_u32 s29, s31, 16384
    buffer_load_dwordx4 v8, s[12:15], s29 offen lds
    s_add_u32 m0, s30, 5120
    s_add_u32 s29, s31, 20480
    buffer_load_dwordx4 v9, s[12:15], s29 offen lds
    s_add_u32 m0, s30, 6144
    s_add_u32 s29, s31, 24576
    buffer_load_dwordx4 v8, s[12:15], s29 offen lds
    s_add_u32 m0, s30, 7168
    s_add_u32 s29, s31, 28672
    buffer_load_dwordx4 v9, s[12:15], s29 offen lds
    s_lshl_b32 s31, s7, 15
    s_add_u32 m0, s30, 8192
    s_add_u32 s29, s31, 0
    buffer_load_dwordx4 v8, s[12:15], s29 offen lds
    s_add_u32 m0, s30, 9216
    s_add_u32 s29, s31, 4096
    buffer_load_dwordx4 v9, s[12:15], s29 offen lds
    s_add_u32 m0, s30, 10240
    s_add_u32 s29, s31, 8192
    buffer_load_dwordx4 v8, s[12:15], s29 offen lds
    s_add_u32 m0, s30, 11264
    s_add_u32 s29, s31, 12288
    buffer_load_dwordx4 v9, s[12:15], s29 offen lds
    s_add_u32 m0, s30, 12288
    s_add_u32 s29, s31, 16384
    buffer_load_dwordx4 v8, s[12:15], s29 offen lds
    s_add_u32 m0, s30, 13312
    s_add_u32 s29, s31, 20480
    buffer_load_dwordx4 v9, s[12:15], s29 offen lds
    s_add_u32 m0, s30, 14336
    s_add_u32 s29, s31, 24576
    buffer_load_dwordx4 v8, s[12:15], s29 offen lds
    s_add_u32 m0, s30, 15360
    s_add_u32 s29, s31, 28672
    buffer_load_dwordx4 v9, s[12:15], s29 offen lds
    s_add_u32 s12, s54, 0xe00000
    s_addc_u32 s13, s55, 0
    s_cmp_eq_u32 s3, 0
    s_cselect_b32 s8, s32, s12
    s_cselect_b32 s9, s33, s13
    s_mov_b32 s10, 0x200000
    s_mov_b32 s11, 0x00020000
    buffer_load_dwordx4 v[32:35], v14, s[8:11], 0 offen offset:0
    buffer_load_dwordx4 v[36:39], v14, s[8:11], 0 offen offset:64
    buffer_load_dwordx4 v[40:43], v14, s[8:11], 0 offen offset:128
    buffer_load_dwordx4 v[44:47], v14, s[8:11], 0 offen offset:192
    s_add_u32 s24, s54, 0x200000
    s_addc_u32 s25, s55, 0
    s_mov_b32 s26, 0x200000
    s_mov_b32 s27, 0x00020000
    s_add_u32 s60, s54, 0x400000
    s_addc_u32 s61, s55, 0
    s_mov_b32 s62, 0x200000
    s_mov_b32 s63, 0x00020000
    v_lshrrev_b32 v4, 2, v2
    v_and_b32 v5, 3, v2
    v_lshrrev_b32 v6, 1, v4
    v_and_b32 v7, 1, v3
    v_lshl_or_b32 v6, v7, 1, v6
    v_lshl_add_u32 v7, v3, 3, v4
    v_lshlrev_b32_e64 v7, 7, v7
    v_lshl_add_u32 v7, v5, 3, v7
    v_add_u32 v7, s30, v7
    v_xor_b32 v4, 0, v6
    v_lshl_add_u32 v48, v4, 5, v7
    v_xor_b32_e64 v4, 1, v6
    v_lshl_add_u32 v49, v4, 5, v7
    v_xor_b32_e64 v4, 2, v6
    v_lshl_add_u32 v50, v4, 5, v7
    v_xor_b32_e64 v4, 3, v6
    v_lshl_add_u32 v51, v4, 5, v7
    s_movk_i32 s28, 2064
    v_mul_lo_u32 v4, v2, s28
    v_add_u32 v164, 65536, v4
    s_lshl_b32 s29, s4, 8
    v_lshl_add_u32 v5, v3, 4, s29
    v_add_u32 v165, v164, v5
    v_sub_u32 v166, v164, v5
    v_add_u32 v166, 1780, v166
    s_lshl_b32 s29, s4, 9
    v_lshl_add_u32 v5, v3, 5, s29
    v_add_u32 v167, v164, v5
    v_mov_b32 v12, 0x80008000
    v_lshlrev_b32_e64 v4, 2, v3
    v_mul_lo_u32 v4, v4, v10
    v_and_b32_e64 v5, 1, v10
    v_mul_lo_u32 v13, v5, v12
    v_and_b32 v5, 31, v4
    v_cvt_f32_u32 v5, v5
    v_mul_f32 v5, 0x3d000000, v5
    v_cos_f32 v6, v5
    v_sin_f32 v7, v5
    v_add_u32_e64 v4, v4, v10
    v_cvt_pk_bf16_f32 v52, v6, v7
    v_xor_b32 v56, v13, v52
    v_and_b32 v5, 31, v4
    v_cvt_f32_u32_e64 v5, v5
    v_mul_f32 v5, 0x3d000000, v5
    v_cos_f32 v6, v5
    v_sin_f32 v7, v5
    v_add_u32_e64 v4, v4, v10
    v_cvt_pk_bf16_f32 v53, v6, v7
    v_xor_b32 v57, v13, v53
    v_and_b32 v5, 31, v4
    v_cvt_f32_u32_e64 v5, v5
    v_mul_f32 v5, 0x3d000000, v5
    v_cos_f32 v6, v5
    v_sin_f32 v7, v5
    v_add_u32_e64 v4, v4, v10
    v_cvt_pk_bf16_f32 v54, v6, v7
    v_xor_b32 v58, v13, v54
    v_and_b32 v5, 31, v4
    v_cvt_f32_u32_e64 v5, v5
    v_mul_f32 v5, 0x3d000000, v5
    v_cos_f32 v6, v5
    v_sin_f32 v7, v5
    v_add_u32_e64 v4, v4, v10
    v_cvt_pk_bf16_f32 v55, v6, v7
    v_xor_b32 v59, v13, v55
    v_lshlrev_b32 v4, 2, v3
    v_mul_lo_u32 v4, v4, v11
    v_and_b32_e64 v5, 1, v11
    v_mul_lo_u32 v13, v5, v12
    v_and_b32 v5, 31, v4
    v_cvt_f32_u32 v5, v5
    v_mul_f32 v5, 0x3d000000, v5
    v_cos_f32 v6, v5
    v_sin_f32 v7, v5
    v_add_u32_e64 v4, v4, v11
    v_cvt_pk_bf16_f32 v60, v6, v7
    v_xor_b32 v64, v13, v60
    v_and_b32 v5, 31, v4
    v_cvt_f32_u32_e64 v5, v5
    v_mul_f32 v5, 0x3d000000, v5
    v_cos_f32 v6, v5
    v_sin_f32 v7, v5
    v_add_u32_e64 v4, v4, v11
    v_cvt_pk_bf16_f32 v61, v6, v7
    v_xor_b32 v65, v13, v61
    v_and_b32 v5, 31, v4
    v_cvt_f32_u32_e64 v5, v5
    v_mul_f32 v5, 0x3d000000, v5
    v_cos_f32 v6, v5
    v_sin_f32 v7, v5
    v_add_u32_e64 v4, v4, v11
    v_cvt_pk_bf16_f32 v62, v6, v7
    v_xor_b32 v66, v13, v62
    v_and_b32 v5, 31, v4
    v_cvt_f32_u32_e64 v5, v5
    v_mul_f32 v5, 0x3d000000, v5
    v_cos_f32 v6, v5
    v_sin_f32 v7, v5
    v_add_u32_e64 v4, v4, v11
    v_cvt_pk_bf16_f32 v63, v6, v7
    v_xor_b32 v67, v13, v63
    s_waitcnt vmcnt(12)
    ds_read_b64_tr_b16 v[68:69], v48 offset:0
    ds_read_b64_tr_b16 v[70:71], v48 offset:512
    ds_read_b64_tr_b16 v[72:73], v48 offset:4096
    ds_read_b64_tr_b16 v[74:75], v48 offset:4608
    ds_read_b64_tr_b16 v[76:77], v49 offset:0
    ds_read_b64_tr_b16 v[78:79], v49 offset:512
    ds_read_b64_tr_b16 v[80:81], v49 offset:4096
    ds_read_b64_tr_b16 v[82:83], v49 offset:4608
    ds_read_b64_tr_b16 v[84:85], v50 offset:0
    ds_read_b64_tr_b16 v[86:87], v50 offset:512
    ds_read_b64_tr_b16 v[88:89], v50 offset:4096
    ds_read_b64_tr_b16 v[90:91], v50 offset:4608
    ds_read_b64_tr_b16 v[92:93], v51 offset:0
    ds_read_b64_tr_b16 v[94:95], v51 offset:512
    ds_read_b64_tr_b16 v[96:97], v51 offset:4096
    ds_read_b64_tr_b16 v[98:99], v51 offset:4608
    s_waitcnt lgkmcnt(12)
    s_nop 0
    v_mfma_f32_16x16x32_bf16 v[132:135], v[68:71], v[52:55], 0
    v_mfma_f32_16x16x32_bf16 v[132:135], v[72:75], v[56:59], v[132:135]
    s_waitcnt lgkmcnt(8)
    s_nop 0
    v_mfma_f32_16x16x32_bf16 v[136:139], v[76:79], v[52:55], 0
    v_mfma_f32_16x16x32_bf16 v[136:139], v[80:83], v[56:59], v[136:139]
    s_waitcnt lgkmcnt(4)
    s_nop 0
    v_mfma_f32_16x16x32_bf16 v[140:143], v[84:87], v[52:55], 0
    v_mfma_f32_16x16x32_bf16 v[140:143], v[88:91], v[56:59], v[140:143]
    s_waitcnt lgkmcnt(0)
    s_nop 0
    v_mfma_f32_16x16x32_bf16 v[144:147], v[92:95], v[52:55], 0
    v_mfma_f32_16x16x32_bf16 v[144:147], v[96:99], v[56:59], v[144:147]
    s_waitcnt vmcnt(4)
    s_nop 0
    ds_read_b64_tr_b16 v[100:101], v48 offset:8192
    ds_read_b64_tr_b16 v[102:103], v48 offset:8704
    ds_read_b64_tr_b16 v[104:105], v48 offset:12288
    ds_read_b64_tr_b16 v[106:107], v48 offset:12800
    ds_read_b64_tr_b16 v[108:109], v49 offset:8192
    ds_read_b64_tr_b16 v[110:111], v49 offset:8704
    ds_read_b64_tr_b16 v[112:113], v49 offset:12288
    ds_read_b64_tr_b16 v[114:115], v49 offset:12800
    ds_read_b64_tr_b16 v[116:117], v50 offset:8192
    ds_read_b64_tr_b16 v[118:119], v50 offset:8704
    ds_read_b64_tr_b16 v[120:121], v50 offset:12288
    ds_read_b64_tr_b16 v[122:123], v50 offset:12800
    ds_read_b64_tr_b16 v[124:125], v51 offset:8192
    ds_read_b64_tr_b16 v[126:127], v51 offset:8704
    ds_read_b64_tr_b16 v[128:129], v51 offset:12288
    ds_read_b64_tr_b16 v[130:131], v51 offset:12800
    s_waitcnt lgkmcnt(12)
    s_nop 0
    v_mfma_f32_16x16x32_bf16 v[148:151], v[100:103], v[60:63], 0
    v_mfma_f32_16x16x32_bf16 v[148:151], v[104:107], v[64:67], v[148:151]
    s_waitcnt lgkmcnt(8)
    s_nop 0
    v_mfma_f32_16x16x32_bf16 v[152:155], v[108:111], v[60:63], 0
    v_mfma_f32_16x16x32_bf16 v[152:155], v[112:115], v[64:67], v[152:155]
    s_waitcnt lgkmcnt(4)
    s_nop 0
    v_mfma_f32_16x16x32_bf16 v[156:159], v[116:119], v[60:63], 0
    v_mfma_f32_16x16x32_bf16 v[156:159], v[120:123], v[64:67], v[156:159]
    s_waitcnt lgkmcnt(0)
    s_nop 0
    v_mfma_f32_16x16x32_bf16 v[160:163], v[124:127], v[60:63], 0
    v_mfma_f32_16x16x32_bf16 v[160:163], v[128:131], v[64:67], v[160:163]
    ds_write_b128 v165, v[132:135] offset:0
    ds_write_b128 v165, v[136:139] offset:64
    ds_write_b128 v165, v[140:143] offset:128
    ds_write_b128 v165, v[144:147] offset:192
    s_nop 3
    s_nop 0
    ds_write_b32 v166, v148 offset:268
    ds_write_b32 v166, v149 offset:264
    ds_write_b32 v166, v150 offset:260
    ds_write_b32 v166, v151 offset:256
    ds_write_b32 v166, v152 offset:204
    ds_write_b32 v166, v153 offset:200
    ds_write_b32 v166, v154 offset:196
    ds_write_b32 v166, v155 offset:192
    ds_write_b32 v166, v156 offset:140
    ds_write_b32 v166, v157 offset:136
    ds_write_b32 v166, v158 offset:132
    ds_write_b32 v166, v159 offset:128
    ds_write_b32 v166, v160 offset:76
    ds_write_b32 v166, v161 offset:72
    ds_write_b32 v166, v162 offset:68
    ds_write_b32 v166, v163 offset:64
    s_cmp_lg_u32 s4, 0
    s_cbranch_scc1 ks_nofix
    v_cmp_gt_u32 vcc, 16, v1
    s_and_saveexec_b64 s[56:57], vcc
    v_mov_b32_e64 v5, 0
    ds_write_b32 v164, v132 offset:1024
    ds_write_b32 v164, v5
    s_mov_b64 exec, s[56:57]
ks_nofix:
    s_waitcnt vmcnt(0)
    v_lshlrev_b32_e64 v100, 16, v32
    v_and_b32 v101, 0xffff0000, v32
    v_lshlrev_b32_e64 v102, 16, v33
    v_and_b32 v103, 0xffff0000, v33
    v_lshlrev_b32_e64 v104, 16, v34
    v_and_b32 v105, 0xffff0000, v34
    v_lshlrev_b32_e64 v106, 16, v35
    v_and_b32 v107, 0xffff0000, v35
    v_lshlrev_b32_e64 v108, 16, v36
    v_and_b32 v109, 0xffff0000, v36
    v_lshlrev_b32_e64 v110, 16, v37
    v_and_b32 v111, 0xffff0000, v37
    v_lshlrev_b32_e64 v112, 16, v38
    v_and_b32 v113, 0xffff0000, v38
    v_lshlrev_b32_e64 v114, 16, v39
    v_and_b32 v115, 0xffff0000, v39
    v_lshlrev_b32_e64 v116, 16, v40
    v_and_b32 v117, 0xffff0000, v40
    v_lshlrev_b32_e64 v118, 16, v41
    v_and_b32 v119, 0xffff0000, v41
    v_lshlrev_b32_e64 v120, 16, v42
    v_and_b32 v121, 0xffff0000, v42
    v_lshlrev_b32_e64 v122, 16, v43
    v_and_b32 v123, 0xffff0000, v43
    v_lshlrev_b32_e64 v124, 16, v44
    v_and_b32 v125, 0xffff0000, v44
    v_lshlrev_b32_e64 v126, 16, v45
    v_and_b32 v127, 0xffff0000, v45
    v_lshlrev_b32_e64 v128, 16, v46
    v_and_b32 v129, 0xffff0000, v46
    v_lshlrev_b32_e64 v130, 16, v47
    v_and_b32 v131, 0xffff0000, v47
    s_waitcnt lgkmcnt(0)
    s_barrier
    ds_read_b128 v[68:71], v167 offset:0
    ds_read_b128 v[72:75], v167 offset:16
    ds_read_b128 v[76:79], v167 offset:128
    ds_read_b128 v[80:83], v167 offset:144
    ds_read_b128 v[84:87], v167 offset:256
    ds_read_b128 v[88:91], v167 offset:272
    ds_read_b128 v[92:95], v167 offset:384
    ds_read_b128 v[96:99], v167 offset:400
    v_mov_b32 v8, 0
    v_mov_b32 v9, 0
    v_mov_b32 v10, 0
    v_mov_b32 v11, 0
    s_waitcnt lgkmcnt(6)
    v_add_f32 v68, v68, v100
    v_add_f32 v69, v69, v101
    v_add_f32 v70, v70, v102
    v_add_f32 v71, v71, v103
    v_add_f32 v72, v72, v104
    v_add_f32 v73, v73, v105
    v_add_f32 v74, v74, v106
    v_add_f32 v75, v75, v107
    v_add_f32 v8, v8, v68
    v_fmac_f32 v9, v68, v68
    v_add_f32 v10, v10, v69
    v_fmac_f32 v11, v69, v69
    v_add_f32 v8, v8, v70
    v_fmac_f32 v9, v70, v70
    v_add_f32 v10, v10, v71
    v_fmac_f32 v11, v71, v71
    v_add_f32 v8, v8, v72
    v_fmac_f32 v9, v72, v72
    v_add_f32 v10, v10, v73
    v_fmac_f32 v11, v73, v73
    v_add_f32 v8, v8, v74
    v_fmac_f32 v9, v74, v74
    v_add_f32 v10, v10, v75
    v_fmac_f32 v11, v75, v75
    s_waitcnt lgkmcnt(4)
    v_add_f32 v76, v76, v108
    v_add_f32 v77, v77, v109
    v_add_f32 v78, v78, v110
    v_add_f32 v79, v79, v111
    v_add_f32 v80, v80, v112
    v_add_f32 v81, v81, v113
    v_add_f32 v82, v82, v114
    v_add_f32 v83, v83, v115
    v_add_f32 v8, v8, v76
    v_fmac_f32 v9, v76, v76
    v_add_f32 v10, v10, v77
    v_fmac_f32 v11, v77, v77
    v_add_f32 v8, v8, v78
    v_fmac_f32 v9, v78, v78
    v_add_f32 v10, v10, v79
    v_fmac_f32 v11, v79, v79
    v_add_f32 v8, v8, v80
    v_fmac_f32 v9, v80, v80
    v_add_f32 v10, v10, v81
    v_fmac_f32 v11, v81, v81
    v_add_f32 v8, v8, v82
    v_fmac_f32 v9, v82, v82
    v_add_f32 v10, v10, v83
    v_fmac_f32 v11, v83, v83
    s_waitcnt lgkmcnt(2)
    v_add_f32 v84, v84, v116
    v_add_f32 v85, v85, v117
    v_add_f32 v86, v86, v118
    v_add_f32 v87, v87, v119
    v_add_f32 v88, v88, v120
    v_add_f32 v89, v89, v121
    v_add_f32 v90, v90, v122
    v_add_f32 v91, v91, v123
    v_add_f32 v8, v8, v84
    v_fmac_f32 v9, v84, v84
    v_add_f32 v10, v10, v85
    v_fmac_f32 v11, v85, v85
    v_add_f32 v8, v8, v86
    v_fmac_f32 v9, v86, v86
    v_add_f32 v10, v10, v87
    v_fmac_f32 v11, v87, v87
    v_add_f32 v8, v8, v88
    v_fmac_f32 v9, v88, v88
    v_add_f32 v10, v10, v89
    v_fmac_f32 v11, v89, v89
    v_add_f32 v8, v8, v90
    v_fmac_f32 v9, v90, v90
    v_add_f32 v10, v10, v91
    v_fmac_f32 v11, v91, v91
    s_waitcnt lgkmcnt(0)
    v_add_f32 v92, v92, v124
    v_add_f32 v93, v93, v125
    v_add_f32 v94, v94, v126
    v_add_f32 v95, v95, v127
    v_add_f32 v96, v96, v128
    v_add_f32 v97, v97, v129
    v_add_f32 v98, v98, v130
    v_add_f32 v99, v99, v131
    v_add_f32 v8, v8, v92
    v_fmac_f32 v9, v92, v92
    v_add_f32 v10, v10, v93
    v_fmac_f32 v11, v93, v93
    v_add_f32 v8, v8, v94
    v_fmac_f32 v9, v94, v94
    v_add_f32 v10, v10, v95
    v_fmac_f32 v11, v95, v95
    v_add_f32 v8, v8, v96
    v_fmac_f32 v9, v96, v96
    v_add_f32 v10, v10, v97
    v_fmac_f32 v11, v97, v97
    v_add_f32 v8, v8, v98
    v_fmac_f32 v9, v98, v98
    v_add_f32 v10, v10, v99
    v_fmac_f32 v11, v99, v99
    v_add_f32 v8, v8, v10
    v_add_f32 v9, v9, v11
    v_xor_b32 v4, 16, v1
    v_lshlrev_b32 v4, 2, v4
    v_xor_b32 v5, 32, v1
    v_lshlrev_b32 v5, 2, v5
    s_nop 0
    v_mov_b32 v10, v8
    v_mov_b32 v11, v9
    s_nop 1
    v_permlane16_swap_b32 v8, v10
    v_permlane16_swap_b32 v9, v11
    s_nop 1
    v_add_f32 v8, v8, v10
    v_add_f32 v9, v9, v11
    v_mov_b32 v10, v8
    v_mov_b32 v11, v9
    s_nop 1
    v_permlane32_swap_b32 v8, v10
    v_permlane32_swap_b32 v9, v11
    s_nop 1
    v_add_f32 v8, v8, v10
    v_add_f32 v9, v9, v11
    s_lshl_b32 s29, s4, 7
    v_lshl_add_u32 v4, v2, 3, s29
    ds_write_b64 v4, v[8:9]
    v_lshlrev_b32_e64 v4, 3, v2
    v_cvt_pk_bf16_f32 v32, v68, v69
    v_cvt_pk_bf16_f32 v33, v70, v71
    v_cvt_pk_bf16_f32 v34, v72, v73
    v_cvt_pk_bf16_f32 v35, v74, v75
    buffer_store_dwordx4 v[32:35], v15, s[24:27], 0 offen offset:0 sc1
    v_cvt_pk_bf16_f32 v36, v76, v77
    v_cvt_pk_bf16_f32 v37, v78, v79
    v_cvt_pk_bf16_f32 v38, v80, v81
    v_cvt_pk_bf16_f32 v39, v82, v83
    buffer_store_dwordx4 v[36:39], v15, s[24:27], 0 offen offset:2048 sc1
    v_cvt_pk_bf16_f32 v40, v84, v85
    v_cvt_pk_bf16_f32 v41, v86, v87
    v_cvt_pk_bf16_f32 v42, v88, v89
    v_cvt_pk_bf16_f32 v43, v90, v91
    v_add_u32 v15, 4096, v15
    buffer_store_dwordx4 v[40:43], v15, s[24:27], 0 offen offset:0 sc1
    v_cvt_pk_bf16_f32 v44, v92, v93
    v_cvt_pk_bf16_f32 v45, v94, v95
    v_cvt_pk_bf16_f32 v46, v96, v97
    v_cvt_pk_bf16_f32 v47, v98, v99
    buffer_store_dwordx4 v[44:47], v15, s[24:27], 0 offen offset:2048 sc1
    s_waitcnt lgkmcnt(0)
    s_barrier
    ds_read_b64 v[8:9], v4
    ds_read_b64 v[10:11], v4 offset:128
    ds_read_b64 v[12:13], v4 offset:256
    ds_read_b64 v[16:17], v4 offset:384
    v_lshrrev_b32 v4, 1, v3
    v_lshlrev_b32 v4, 10, v4
    v_and_b32_e64 v5, 1, v3
    v_lshl_add_u32 v4, v5, 9, v4
    v_lshl_add_u32 v4, v2, 4, v4
    s_lshl_b32 s28, s5, 15
    s_lshl_b32 s29, s4, 13
    s_add_u32 s28, s28, s29
    s_lshl_b32 s29, s6, 8
    s_add_u32 s28, s28, s29
    v_add_u32 v4, s28, v4
    s_waitcnt lgkmcnt(0)
    v_add_f32 v8, v8, v10
    v_add_f32 v9, v9, v11
    v_add_f32 v12, v12, v16
    v_add_f32 v13, v13, v17
    v_add_f32 v8, v8, v12
    v_add_f32_e64 v9, v9, v13
    v_mul_f32 v8, 0x3b000000, v8
    v_mul_f32 v9, 0x3b000000, v9
    v_fma_f32 v9, -v8, v8, v9
    v_add_f32 v9, 0x3727c5ac, v9
    v_rsq_f32 v9, v9
    s_nop 0
    v_mul_f32 v8, v8, v9
    v_sub_f32 v8, 0, v8
    v_fma_f32 v68, v68, v9, v8
    v_fma_f32 v69, v69, v9, v8
    v_cvt_pk_bf16_f32 v116, v68, v69
    v_fma_f32 v70, v70, v9, v8
    v_fma_f32 v71, v71, v9, v8
    v_cvt_pk_bf16_f32 v117, v70, v71
    v_fma_f32 v72, v72, v9, v8
    v_fma_f32 v73, v73, v9, v8
    v_cvt_pk_bf16_f32 v118, v72, v73
    v_fma_f32 v74, v74, v9, v8
    v_fma_f32 v75, v75, v9, v8
    v_cvt_pk_bf16_f32 v119, v74, v75
    buffer_store_dwordx4 v[116:119], v4, s[60:63], 0 offen offset:0 sc1
    v_fma_f32 v76, v76, v9, v8
    v_fma_f32 v77, v77, v9, v8
    v_cvt_pk_bf16_f32 v120, v76, v77
    v_fma_f32 v78, v78, v9, v8
    v_fma_f32 v79, v79, v9, v8
    v_cvt_pk_bf16_f32 v121, v78, v79
    v_fma_f32 v80, v80, v9, v8
    v_fma_f32 v81, v81, v9, v8
    v_cvt_pk_bf16_f32 v122, v80, v81
    v_fma_f32 v82, v82, v9, v8
    v_fma_f32 v83, v83, v9, v8
    v_cvt_pk_bf16_f32 v123, v82, v83
    buffer_store_dwordx4 v[120:123], v4, s[60:63], 0 offen offset:2048 sc1
    v_fma_f32 v84, v84, v9, v8
    v_fma_f32 v85, v85, v9, v8
    v_cvt_pk_bf16_f32 v124, v84, v85
    v_fma_f32 v86, v86, v9, v8
    v_fma_f32 v87, v87, v9, v8
    v_cvt_pk_bf16_f32 v125, v86, v87
    v_fma_f32 v88, v88, v9, v8
    v_fma_f32 v89, v89, v9, v8
    v_cvt_pk_bf16_f32 v126, v88, v89
    v_fma_f32 v90, v90, v9, v8
    v_fma_f32 v91, v91, v9, v8
    v_cvt_pk_bf16_f32 v127, v90, v91
    v_add_u32 v4, 4096, v4
    buffer_store_dwordx4 v[124:127], v4, s[60:63], 0 offen offset:0 sc1
    v_fma_f32 v92, v92, v9, v8
    v_fma_f32 v93, v93, v9, v8
    v_cvt_pk_bf16_f32 v128, v92, v93
    v_fma_f32 v94, v94, v9, v8
    v_fma_f32 v95, v95, v9, v8
    v_cvt_pk_bf16_f32 v129, v94, v95
    v_fma_f32 v96, v96, v9, v8
    v_fma_f32 v97, v97, v9, v8
    v_cvt_pk_bf16_f32 v130, v96, v97
    v_fma_f32 v98, v98, v9, v8
    v_fma_f32 v99, v99, v9, v8
    v_cvt_pk_bf16_f32 v131, v98, v99
    buffer_store_dwordx4 v[128:131], v4, s[60:63], 0 offen offset:2048 sc1
ks_exit:
    s_endpgm
ks_prep:
    s_cmp_lg_u32 s3, 0
    s_cbranch_scc1 ks_exit
    s_cmp_ge_u32 s2, 240
    s_cbranch_scc1 ks_exit
    s_sub_u32 s95, s2, 128
    s_waitcnt lgkmcnt(0)
    s_mov_b32 s40, s44
    s_mov_b32 s41, s45
    s_mov_b32 s42, 0x1c0000
    s_mov_b32 s43, 0x00020000
    s_mov_b32 s44, s46
    s_mov_b32 s45, s47
    s_mov_b32 s46, 0x1c0000
    s_mov_b32 s47, 0x00020000
    s_mov_b32 s60, s48
    s_mov_b32 s61, s49
    s_mov_b32 s62, 0x1c0000
    s_mov_b32 s63, 0x00020000
    s_add_u32 s8, s54, 0x1000000
    s_addc_u32 s9, s55, 0
    s_mov_b32 s10, 0x380000
    s_mov_b32 s11, 0x00020000
    s_add_u32 s12, s54, 0x1400000
    s_addc_u32 s13, s55, 0
    s_mov_b32 s14, 0x1c0000
    s_mov_b32 s15, 0x00020000
    v_and_b32 v6, 7, v1
    v_bfe_u32 v7, v1, 4, 1
    v_lshlrev_b32 v7, 1, v7
    v_xor_b32 v20, v6, v7
    s_lshl_b32 s31, s4, 11
    s_add_u32 s7, s95, 0
    s_lshr_b32 s28, s7, 3
    s_and_b32 s29, s7, 7
    v_lshrrev_b32 v5, 3, v1
    s_lshl_b32 s7, s4, 4
    v_add_u32 v5, s7, v5
    s_lshl_b32 s7, s29, 6
    v_add_u32 v4, s7, v5
    s_movk_i32 s7, 3584
    v_mul_lo_u32 v4, v4, s7
    s_lshl_b32 s7, s28, 7
    v_add_u32 v4, s7, v4
    v_lshl_add_u32 v22, v20, 4, v4
    v_xor_b32_e64 v23, 64, v22
    v_add_u32 v23, 28672, v23
    s_lshl_b32 s7, s28, 6
    v_add_u32 v4, s7, v5
    v_lshlrev_b32 v4, 10, v4
    s_lshl_b32 s7, s29, 7
    v_add_u32_e64 v4, s7, v4
    v_lshl_add_u32 v24, v20, 4, v4
    v_xor_b32_e64 v25, 64, v24
    v_add_u32 v25, 8192, v25
    s_add_u32 m0, s31, 0
    s_nop 0
    buffer_load_dwordx4 v22, s[40:43], 0 offen lds
    s_add_u32 m0, s31, 1024
    s_nop 0
    s_nop 0
    buffer_load_dwordx4 v23, s[40:43], 0 offen lds
    s_add_u32 m0, s31, 8192
    s_nop 0
    s_nop 0
    buffer_load_dwordx4 v22, s[44:47], 0 offen lds
    s_add_u32 m0, s31, 9216
    s_nop 0
    s_nop 0
    buffer_load_dwordx4 v23, s[44:47], 0 offen lds
    s_add_u32 s7, s95, 112
    s_lshr_b32 s28, s7, 3
    s_and_b32 s29, s7, 7
    v_lshrrev_b32 v5, 3, v1
    s_lshl_b32 s7, s4, 4
    v_add_u32 v5, s7, v5
    s_lshl_b32 s7, s29, 6
    v_add_u32 v4, s7, v5
    s_movk_i32 s7, 3584
    v_mul_lo_u32 v4, v4, s7
    s_lshl_b32 s7, s28, 7
    v_add_u32 v4, s7, v4
    v_lshl_add_u32 v22, v20, 4, v4
    v_xor_b32_e64 v23, 64, v22
    v_add_u32 v23, 28672, v23
    s_lshl_b32 s7, s28, 6
    v_add_u32 v4, s7, v5
    v_lshlrev_b32 v4, 10, v4
    s_lshl_b32 s7, s29, 7
    v_add_u32_e64 v4, s7, v4
    v_lshl_add_u32 v24, v20, 4, v4
    v_xor_b32_e64 v25, 64, v24
    v_add_u32 v25, 8192, v25
    s_add_u32 m0, s31, 24576
    s_nop 0
    s_nop 0
    buffer_load_dwordx4 v22, s[40:43], 0 offen lds
    s_add_u32 m0, s31, 25600
    s_nop 0
    s_nop 0
    buffer_load_dwordx4 v23, s[40:43], 0 offen lds
    s_add_u32 m0, s31, 32768
    s_nop 0
    s_nop 0
    buffer_load_dwordx4 v22, s[44:47], 0 offen lds
    s_add_u32 m0, s31, 33792
    s_nop 0
    s_nop 0
    buffer_load_dwordx4 v23, s[44:47], 0 offen lds
    v_lshrrev_b32 v4, 2, v2
    v_and_b32 v5, 3, v2
    v_lshrrev_b32_e64 v6, 5, v1
    v_bfe_u32 v7, v1, 4, 1
    v_lshrrev_b32_e64 v8, 1, v4
    v_lshl_or_b32 v9, v6, 1, v8
    s_lshl_b32 s7, s4, 4
    v_lshl_add_u32 v10, v6, 3, v4
    v_add_u32 v10, s7, v10
    v_lshlrev_b32_e64 v10, 7, v10
    v_lshl_add_u32 v10, v5, 3, v10
    v_lshl_add_u32 v10, v7, 13, v10
    v_lshl_add_u32 v11, v6, 2, v4
    v_add_u32 v11, s7, v11
    v_lshlrev_b32 v11, 7, v11
    v_lshl_add_u32 v11, v5, 3, v11
    v_add_u32 v11, 16384, v11
    s_waitcnt vmcnt(4)
    v_xor_b32 v12, 0, v9
    v_lshl_add_u32 v12, v12, 5, v10
    ds_read_b64_tr_b16 v[32:33], v12 offset:0
    ds_read_b64_tr_b16 v[34:35], v12 offset:512
    v_xor_b32_e64 v12, 1, v9
    v_lshl_add_u32 v12, v12, 5, v10
    ds_read_b64_tr_b16 v[36:37], v12 offset:0
    ds_read_b64_tr_b16 v[38:39], v12 offset:512
    v_xor_b32_e64 v12, 2, v9
    v_lshl_add_u32 v12, v12, 5, v10
    ds_read_b64_tr_b16 v[40:41], v12 offset:0
    ds_read_b64_tr_b16 v[42:43], v12 offset:512
    v_xor_b32_e64 v12, 3, v9
    v_lshl_add_u32 v12, v12, 5, v10
    ds_read_b64_tr_b16 v[44:45], v12 offset:0
    ds_read_b64_tr_b16 v[46:47], v12 offset:512
    s_add_u32 s7, s95, 0
    s_lshr_b32 s28, s7, 3
    s_and_b32 s29, s7, 7
    s_lshl_b32 s7, s28, 7
    s_lshl_b32 s30, s29, 2
    s_add_u32 s7, s7, s30
    s_add_u32 s7, s7, s4
    s_lshl_b32 s7, s7, 10
    v_lshl_add_u32 v14, v1, 4, s7
    s_mul_i32 s7, s29, 224
    s_lshl_b32 s30, s28, 2
    s_add_u32 s7, s7, s30
    s_add_u32 s7, s7, s4
    s_lshl_b32 s7, s7, 10
    v_lshl_add_u32 v15, v1, 4, s7
    s_waitcnt lgkmcnt(0)
    s_mov_b32 s7, 0
    buffer_store_dwordx4 v[32:35], v14, s[8:11], s7 offen sc1
    s_mov_b32 s7, 32768
    buffer_store_dwordx4 v[36:39], v14, s[8:11], s7 offen sc1
    s_mov_b32 s7, 65536
    buffer_store_dwordx4 v[40:43], v14, s[8:11], s7 offen sc1
    s_mov_b32 s7, 98304
    buffer_store_dwordx4 v[44:47], v14, s[8:11], s7 offen sc1
    s_nop 1
    s_waitcnt vmcnt(0)
    v_xor_b32_e64 v12, 0, v9
    v_lshl_add_u32 v12, v12, 5, v10
    ds_read_b64_tr_b16 v[32:33], v12 offset:24576
    ds_read_b64_tr_b16 v[34:35], v12 offset:25088
    v_xor_b32_e64 v12, 1, v9
    v_lshl_add_u32 v12, v12, 5, v10
    ds_read_b64_tr_b16 v[36:37], v12 offset:24576
    ds_read_b64_tr_b16 v[38:39], v12 offset:25088
    v_xor_b32_e64 v12, 2, v9
    v_lshl_add_u32 v12, v12, 5, v10
    ds_read_b64_tr_b16 v[40:41], v12 offset:24576
    ds_read_b64_tr_b16 v[42:43], v12 offset:25088
    v_xor_b32_e64 v12, 3, v9
    v_lshl_add_u32 v12, v12, 5, v10
    ds_read_b64_tr_b16 v[44:45], v12 offset:24576
    ds_read_b64_tr_b16 v[46:47], v12 offset:25088
    s_add_u32 s7, s95, 112
    s_lshr_b32 s28, s7, 3
    s_and_b32 s29, s7, 7
    s_lshl_b32 s7, s28, 7
    s_lshl_b32 s30, s29, 2
    s_add_u32 s7, s7, s30
    s_add_u32 s7, s7, s4
    s_lshl_b32 s7, s7, 10
    v_lshl_add_u32 v14, v1, 4, s7
    s_mul_i32 s7, s29, 224
    s_lshl_b32 s30, s28, 2
    s_add_u32 s7, s7, s30
    s_add_u32 s7, s7, s4
    s_lshl_b32 s7, s7, 10
    v_lshl_add_u32 v15, v1, 4, s7
    s_waitcnt lgkmcnt(0)
    s_mov_b32 s7, 0
    s_nop 0
    buffer_store_dwordx4 v[32:35], v14, s[8:11], s7 offen sc1
    s_mov_b32 s7, 32768
    buffer_store_dwordx4 v[36:39], v14, s[8:11], s7 offen sc1
    s_mov_b32 s7, 65536
    buffer_store_dwordx4 v[40:43], v14, s[8:11], s7 offen sc1
    s_mov_b32 s7, 98304
    buffer_store_dwordx4 v[44:47], v14, s[8:11], s7 offen sc1
    s_endpgm
.p2align 8
.globl kb_kernel
.type kb_kernel,@function
kb_kernel:
    s_load_dwordx16 s[32:47], s[0:1], 0
    s_load_dwordx8 s[48:55], s[0:1], 64
    v_and_b32 v1, 63, v0
    v_lshrrev_b32 v4, 6, v0
    v_and_b32_e64 v2, 15, v0
    v_bfe_u32 v3, v0, 4, 2
    v_readfirstlane_b32 s4, v4
    s_cmp_ge_u32 s2, 256
    s_cbranch_scc1 kb_exit
    s_and_b32 s5, s2, 3
    s_lshl_b32 s5, s5, 2
    s_bfe_u32 s6, s2, 0x20003
    s_add_u32 s5, s5, s6
    s_bfe_u32 s6, s2, 0x10002
    s_lshl_b32 s6, s6, 3
    s_lshr_b32 s7, s2, 5
    s_add_u32 s6, s6, s7
    s_lshl_b32 s7, s5, 2
    s_add_u32 s7, s7, s4
    s_lshl_b32 s28, s7, 15
    v_lshrrev_b32 v9, 1, v3
    v_lshlrev_b32 v9, 10, v9
    v_and_b32 v10, 1, v3
    v_lshl_add_u32 v9, v10, 9, v9
    v_lshl_add_u32 v9, v2, 4, v9
    v_add_u32 v4, s28, v9
    v_lshlrev_b32 v5, 4, v1
    s_mul_i32 s29, s6, 7
    s_lshl_b32 s30, s29, 15
    s_lshl_b32 s31, s4, 10
    s_add_u32 s58, s30, s31
    s_mul_i32 s28, s7, 112
    s_add_u32 s28, s28, s29
    s_lshl_b32 s28, s28, 10
    v_lshrrev_b32 v11, 1, v3
    v_lshlrev_b32 v11, 3, v11
    v_lshl_add_u32 v11, v10, 9, v11
    v_lshl_add_u32 v11, v2, 4, v11
    v_add_u32_e64 v6, s28, v11
    s_mov_b32 s57, 0xbdd2d3e8
    v_mov_b32 v52, 0xc0135761
    s_waitcnt lgkmcnt(0)
    s_add_u32 s8, s54, 0x400000
    s_addc_u32 s9, s55, 0
    s_mov_b32 s10, 0x200000
    s_mov_b32 s11, 0x00020000
    s_add_u32 s12, s54, 0x1000000
    s_addc_u32 s13, s55, 0
    s_mov_b32 s14, 0x380000
    s_mov_b32 s15, 0x00020000
    s_add_u32 s16, s54, 0x600000
    s_addc_u32 s17, s55, 0
    s_mov_b32 s18, 0x700000
    s_mov_b32 s19, 0x00020000
    s_lshl_b32 s62, s4, 13
    s_add_u32 s60, s62, 65536
    s_add_u32 s61, s30, s60
    s_mov_b32 s56, 0
    s_add_u32 m0, s31, 0
    s_add_u32 s59, s58, 0
    s_nop 0
    buffer_load_dwordx4 v5, s[12:15], s59 offen lds
    s_add_u32 m0, s31, 32768
    s_add_u32 s59, s59, 32768
    buffer_load_dwordx4 v5, s[12:15], s59 offen lds
    buffer_load_dwordx4 v[128:131], v4, s[8:11], s56 offen offset:0
    buffer_load_dwordx4 v[132:135], v4, s[8:11], s56 offen offset:256
    buffer_load_dwordx4 v[136:139], v4, s[8:11], s56 offen offset:2048
    buffer_load_dwordx4 v[140:143], v4, s[8:11], s56 offen offset:2304
    s_mov_b32 s56, 4096
    s_add_u32 m0, s31, 4096
    s_add_u32 s59, s58, 4096
    buffer_load_dwordx4 v5, s[12:15], s59 offen lds
    s_add_u32 m0, s31, 36864
    s_add_u32 s59, s59, 32768
    buffer_load_dwordx4 v5, s[12:15], s59 offen lds
    buffer_load_dwordx4 v[144:147], v4, s[8:11], s56 offen offset:0
    buffer_load_dwordx4 v[148:151], v4, s[8:11], s56 offen offset:256
    buffer_load_dwordx4 v[152:155], v4, s[8:11], s56 offen offset:2048
    buffer_load_dwordx4 v[156:159], v4, s[8:11], s56 offen offset:2304
    s_mov_b32 s56, 8192
    s_add_u32 m0, s31, 8192
    s_add_u32 s59, s58, 8192
    buffer_load_dwordx4 v5, s[12:15], s59 offen lds
    s_add_u32 m0, s31, 40960
    s_add_u32 s59, s59, 32768
    buffer_load_dwordx4 v5, s[12:15], s59 offen lds
    buffer_load_dwordx4 v[160:163], v4, s[8:11], s56 offen offset:0
    buffer_load_dwordx4 v[164:167], v4, s[8:11], s56 offen offset:256
    buffer_load_dwordx4 v[168:171], v4, s[8:11], s56 offen offset:2048
    buffer_load_dwordx4 v[172:175], v4, s[8:11], s56 offen offset:2304
    s_mov_b32 s56, 12288
    s_add_u32 m0, s31, 12288
    s_add_u32 s59, s58, 12288
    buffer_load_dwordx4 v5, s[12:15], s59 offen lds
    s_add_u32 m0, s31, 45056
    s_add_u32 s59, s59, 32768
    buffer_load_dwordx4 v5, s[12:15], s59 offen lds
    buffer_load_dwordx4 v[176:179], v4, s[8:11], s56 offen offset:0
    buffer_load_dwordx4 v[180:183], v4, s[8:11], s56 offen offset:256
    buffer_load_dwordx4 v[184:187], v4, s[8:11], s56 offen offset:2048
    buffer_load_dwordx4 v[188:191], v4, s[8:11], s56 offen offset:2304
    s_waitcnt vmcnt(18)
    s_barrier
    ds_read_b128 v[64:67], v9 offset:0
    ds_read_b128 v[80:83], v9 offset:32768
    ds_read_b128 v[68:71], v9 offset:256
    ds_read_b128 v[84:87], v9 offset:33024
    ds_read_b128 v[72:75], v9 offset:2048
    ds_read_b128 v[88:91], v9 offset:34816
    ds_read_b128 v[76:79], v9 offset:2304
    ds_read_b128 v[92:95], v9 offset:35072
    s_waitcnt lgkmcnt(7)
    s_nop 0
    v_mfma_f32_16x16x32_bf16 v[16:19], v[64:67], v[128:131], 0
    v_mfma_f32_16x16x32_bf16 v[20:23], v[64:67], v[132:135], 0
    s_waitcnt lgkmcnt(6)
    s_nop 0
    v_mfma_f32_16x16x32_bf16 v[32:35], v[80:83], v[128:131], 0
    v_mfma_f32_16x16x32_bf16 v[36:39], v[80:83], v[132:135], 0
    s_waitcnt lgkmcnt(5)
    s_nop 0
    v_mfma_f32_16x16x32_bf16 v[24:27], v[68:71], v[128:131], 0
    v_mfma_f32_16x16x32_bf16 v[28:31], v[68:71], v[132:135], 0
    s_waitcnt lgkmcnt(4)
    s_nop 0
    v_mfma_f32_16x16x32_bf16 v[40:43], v[84:87], v[128:131], 0
    v_mfma_f32_16x16x32_bf16 v[44:47], v[84:87], v[132:135], 0
    s_waitcnt lgkmcnt(3)
    s_nop 0
    v_mfma_f32_16x16x32_bf16 v[16:19], v[72:75], v[136:139], v[16:19]
    v_mfma_f32_16x16x32_bf16 v[20:23], v[72:75], v[140:143], v[20:23]
    s_waitcnt lgkmcnt(2)
    s_nop 0
    v_mfma_f32_16x16x32_bf16 v[32:35], v[88:91], v[136:139], v[32:35]
    v_mfma_f32_16x16x32_bf16 v[36:39], v[88:91], v[140:143], v[36:39]
    s_waitcnt lgkmcnt(1)
    s_nop 0
    v_mfma_f32_16x16x32_bf16 v[24:27], v[76:79], v[136:139], v[24:27]
    v_mfma_f32_16x16x32_bf16 v[28:31], v[76:79], v[140:143], v[28:31]
    s_waitcnt lgkmcnt(0)
    s_nop 0
    v_mfma_f32_16x16x32_bf16 v[40:43], v[92:95], v[136:139], v[40:43]
    v_mfma_f32_16x16x32_bf16 v[44:47], v[92:95], v[140:143], v[44:47]
    s_mov_b32 s56, 16384
    s_add_u32 m0, s31, 16384
    s_add_u32 s59, s58, 16384
    buffer_load_dwordx4 v5, s[12:15], s59 offen lds
    s_add_u32 m0, s31, 49152
    s_add_u32 s59, s59, 32768
    buffer_load_dwordx4 v5, s[12:15], s59 offen lds
    buffer_load_dwordx4 v[192:195], v4, s[8:11], s56 offen offset:0
    buffer_load_dwordx4 v[196:199], v4, s[8:11], s56 offen offset:256
    buffer_load_dwordx4 v[200:203], v4, s[8:11], s56 offen offset:2048
    buffer_load_dwordx4 v[204:207], v4, s[8:11], s56 offen offset:2304
    s_waitcnt vmcnt(18)
    s_barrier
    ds_read_b128 v[96:99], v9 offset:4096
    ds_read_b128 v[112:115], v9 offset:36864
    ds_read_b128 v[100:103], v9 offset:4352
    ds_read_b128 v[116:119], v9 offset:37120
    ds_read_b128 v[104:107], v9 offset:6144
    ds_read_b128 v[120:123], v9 offset:38912
    ds_read_b128 v[108:111], v9 offset:6400
    ds_read_b128 v[124:127], v9 offset:39168
    s_waitcnt lgkmcnt(7)
    s_nop 0
    v_mfma_f32_16x16x32_bf16 v[16:19], v[96:99], v[144:147], v[16:19]
    v_mfma_f32_16x16x32_bf16 v[20:23], v[96:99], v[148:151], v[20:23]
    s_waitcnt lgkmcnt(6)
    s_nop 0
    v_mfma_f32_16x16x32_bf16 v[32:35], v[112:115], v[144:147], v[32:35]
    v_mfma_f32_16x16x32_bf16 v[36:39], v[112:115], v[148:151], v[36:39]
    s_waitcnt lgkmcnt(5)
    s_nop 0
    v_mfma_f32_16x16x32_bf16 v[24:27], v[100:103], v[144:147], v[24:27]
    v_mfma_f32_16x16x32_bf16 v[28:31], v[100:103], v[148:151], v[28:31]
    s_waitcnt lgkmcnt(4)
    s_nop 0
    v_mfma_f32_16x16x32_bf16 v[40:43], v[116:119], v[144:147], v[40:43]
    v_mfma_f32_16x16x32_bf16 v[44:47], v[116:119], v[148:151], v[44:47]
    s_waitcnt lgkmcnt(3)
    s_nop 0
    v_mfma_f32_16x16x32_bf16 v[16:19], v[104:107], v[152:155], v[16:19]
    v_mfma_f32_16x16x32_bf16 v[20:23], v[104:107], v[156:159], v[20:23]
    s_waitcnt lgkmcnt(2)
    s_nop 0
    v_mfma_f32_16x16x32_bf16 v[32:35], v[120:123], v[152:155], v[32:35]
    v_mfma_f32_16x16x32_bf16 v[36:39], v[120:123], v[156:159], v[36:39]
    s_waitcnt lgkmcnt(1)
    s_nop 0
    v_mfma_f32_16x16x32_bf16 v[24:27], v[108:111], v[152:155], v[24:27]
    v_mfma_f32_16x16x32_bf16 v[28:31], v[108:111], v[156:159], v[28:31]
    s_waitcnt lgkmcnt(0)
    s_nop 0
    v_mfma_f32_16x16x32_bf16 v[40:43], v[124:127], v[152:155], v[40:43]
    v_mfma_f32_16x16x32_bf16 v[44:47], v[124:127], v[156:159], v[44:47]
    s_mov_b32 s56, 20480
    s_add_u32 m0, s31, 20480
    s_add_u32 s59, s58, 20480
    buffer_load_dwordx4 v5, s[12:15], s59 offen lds
    s_add_u32 m0, s31, 53248
    s_add_u32 s59, s59, 32768
    buffer_load_dwordx4 v5, s[12:15], s59 offen lds
    buffer_load_dwordx4 v[208:211], v4, s[8:11], s56 offen offset:0
    buffer_load_dwordx4 v[212:215], v4, s[8:11], s56 offen offset:256
    buffer_load_dwordx4 v[216:219], v4, s[8:11], s56 offen offset:2048
    buffer_load_dwordx4 v[220:223], v4, s[8:11], s56 offen offset:2304
    s_waitcnt vmcnt(18)
    s_barrier
    ds_read_b128 v[64:67], v9 offset:8192
    ds_read_b128 v[80:83], v9 offset:40960
    ds_read_b128 v[68:71], v9 offset:8448
    ds_read_b128 v[84:87], v9 offset:41216
    ds_read_b128 v[72:75], v9 offset:10240
    ds_read_b128 v[88:91], v9 offset:43008
    ds_read_b128 v[76:79], v9 offset:10496
    ds_read_b128 v[92:95], v9 offset:43264
    s_waitcnt lgkmcnt(7)
    s_nop 0
    v_mfma_f32_16x16x32_bf16 v[16:19], v[64:67], v[160:163], v[16:19]
    v_mfma_f32_16x16x32_bf16 v[20:23], v[64:67], v[164:167], v[20:23]
    s_waitcnt lgkmcnt(6)
    s_nop 0
    v_mfma_f32_16x16x32_bf16 v[32:35], v[80:83], v[160:163], v[32:35]
    v_mfma_f32_16x16x32_bf16 v[36:39], v[80:83], v[164:167], v[36:39]
    s_waitcnt lgkmcnt(5)
    s_nop 0
    v_mfma_f32_16x16x32_bf16 v[24:27], v[68:71], v[160:163], v[24:27]
    v_mfma_f32_16x16x32_bf16 v[28:31], v[68:71], v[164:167], v[28:31]
    s_waitcnt lgkmcnt(4)
    s_nop 0
    v_mfma_f32_16x16x32_bf16 v[40:43], v[84:87], v[160:163], v[40:43]
    v_mfma_f32_16x16x32_bf16 v[44:47], v[84:87], v[164:167], v[44:47]
    s_waitcnt lgkmcnt(3)
    s_nop 0
    v_mfma_f32_16x16x32_bf16 v[16:19], v[72:75], v[168:171], v[16:19]
    v_mfma_f32_16x16x32_bf16 v[20:23], v[72:75], v[172:175], v[20:23]
    s_waitcnt lgkmcnt(2)
    s_nop 0
    v_mfma_f32_16x16x32_bf16 v[32:35], v[88:91], v[168:171], v[32:35]
    v_mfma_f32_16x16x32_bf16 v[36:39], v[88:91], v[172:175], v[36:39]
    s_waitcnt lgkmcnt(1)
    s_nop 0
    v_mfma_f32_16x16x32_bf16 v[24:27], v[76:79], v[168:171], v[24:27]
    v_mfma_f32_16x16x32_bf16 v[28:31], v[76:79], v[172:175], v[28:31]
    s_waitcnt lgkmcnt(0)
    s_nop 0
    v_mfma_f32_16x16x32_bf16 v[40:43], v[92:95], v[168:171], v[40:43]
    v_mfma_f32_16x16x32_bf16 v[44:47], v[92:95], v[172:175], v[44:47]
    s_mov_b32 s56, 24576
    s_add_u32 m0, s31, 24576
    s_add_u32 s59, s58, 24576
    buffer_load_dwordx4 v5, s[12:15], s59 offen lds
    s_add_u32 m0, s31, 57344
    s_add_u32 s59, s59, 32768
    buffer_load_dwordx4 v5, s[12:15], s59 offen lds
    buffer_load_dwordx4 v[224:227], v4, s[8:11], s56 offen offset:0
    buffer_load_dwordx4 v[228:231], v4, s[8:11], s56 offen offset:256
    buffer_load_dwordx4 v[232:235], v4, s[8:11], s56 offen offset:2048
    buffer_load_dwordx4 v[236:239], v4, s[8:11], s56 offen offset:2304
    s_waitcnt vmcnt(18)
    s_barrier
    ds_read_b128 v[96:99], v9 offset:12288
    ds_read_b128 v[112:115], v9 offset:45056
    ds_read_b128 v[100:103], v9 offset:12544
    ds_read_b128 v[116:119], v9 offset:45312
    ds_read_b128 v[104:107], v9 offset:14336
    ds_read_b128 v[120:123], v9 offset:47104
    ds_read_b128 v[108:111], v9 offset:14592
    ds_read_b128 v[124:127], v9 offset:47360
    s_waitcnt lgkmcnt(7)
    s_nop 0
    v_mfma_f32_16x16x32_bf16 v[16:19], v[96:99], v[176:179], v[16:19]
    v_mfma_f32_16x16x32_bf16 v[20:23], v[96:99], v[180:183], v[20:23]
    s_waitcnt lgkmcnt(6)
    s_nop 0
    v_mfma_f32_16x16x32_bf16 v[32:35], v[112:115], v[176:179], v[32:35]
    v_mfma_f32_16x16x32_bf16 v[36:39], v[112:115], v[180:183], v[36:39]
    s_waitcnt lgkmcnt(5)
    s_nop 0
    v_mfma_f32_16x16x32_bf16 v[24:27], v[100:103], v[176:179], v[24:27]
    v_mfma_f32_16x16x32_bf16 v[28:31], v[100:103], v[180:183], v[28:31]
    s_waitcnt lgkmcnt(4)
    s_nop 0
    v_mfma_f32_16x16x32_bf16 v[40:43], v[116:119], v[176:179], v[40:43]
    v_mfma_f32_16x16x32_bf16 v[44:47], v[116:119], v[180:183], v[44:47]
    s_waitcnt lgkmcnt(3)
    s_nop 0
    v_mfma_f32_16x16x32_bf16 v[16:19], v[104:107], v[184:187], v[16:19]
    v_mfma_f32_16x16x32_bf16 v[20:23], v[104:107], v[188:191], v[20:23]
    s_waitcnt lgkmcnt(2)
    s_nop 0
    v_mfma_f32_16x16x32_bf16 v[32:35], v[120:123], v[184:187], v[32:35]
    v_mfma_f32_16x16x32_bf16 v[36:39], v[120:123], v[188:191], v[36:39]
    s_waitcnt lgkmcnt(1)
    s_nop 0
    v_mfma_f32_16x16x32_bf16 v[24:27], v[108:111], v[184:187], v[24:27]
    v_mfma_f32_16x16x32_bf16 v[28:31], v[108:111], v[188:191], v[28:31]
    s_waitcnt lgkmcnt(0)
    s_nop 0
    v_mfma_f32_16x16x32_bf16 v[40:43], v[124:127], v[184:187], v[40:43]
    v_mfma_f32_16x16x32_bf16 v[44:47], v[124:127], v[188:191], v[44:47]
    s_mov_b32 s56, 28672
    s_add_u32 m0, s31, 28672
    s_add_u32 s59, s58, 28672
    buffer_load_dwordx4 v5, s[12:15], s59 offen lds
    s_add_u32 m0, s31, 61440
    s_add_u32 s59, s59, 32768
    buffer_load_dwordx4 v5, s[12:15], s59 offen lds
    buffer_load_dwordx4 v[240:243], v4, s[8:11], s56 offen offset:0
    buffer_load_dwordx4 v[244:247], v4, s[8:11], s56 offen offset:256
    buffer_load_dwordx4 v[248:251], v4, s[8:11], s56 offen offset:2048
    buffer_load_dwordx4 v[252:255], v4, s[8:11], s56 offen offset:2304
    s_waitcnt vmcnt(18)
    s_barrier
    ds_read_b128 v[64:67], v9 offset:16384
    ds_read_b128 v[80:83], v9 offset:49152
    ds_read_b128 v[68:71], v9 offset:16640
    ds_read_b128 v[84:87], v9 offset:49408
    ds_read_b128 v[72:75], v9 offset:18432
    ds_read_b128 v[88:91], v9 offset:51200
    ds_read_b128 v[76:79], v9 offset:18688
    ds_read_b128 v[92:95], v9 offset:51456
    s_waitcnt lgkmcnt(7)
    s_nop 0
    v_mfma_f32_16x16x32_bf16 v[16:19], v[64:67], v[192:195], v[16:19]
    v_mfma_f32_16x16x32_bf16 v[20:23], v[64:67], v[196:199], v[20:23]
    s_waitcnt lgkmcnt(6)
    s_nop 0
    v_mfma_f32_16x16x32_bf16 v[32:35], v[80:83], v[192:195], v[32:35]
    v_mfma_f32_16x16x32_bf16 v[36:39], v[80:83], v[196:199], v[36:39]
    s_waitcnt lgkmcnt(5)
    s_nop 0
    v_mfma_f32_16x16x32_bf16 v[24:27], v[68:71], v[192:195], v[24:27]
    v_mfma_f32_16x16x32_bf16 v[28:31], v[68:71], v[196:199], v[28:31]
    s_waitcnt lgkmcnt(4)
    s_nop 0
    v_mfma_f32_16x16x32_bf16 v[40:43], v[84:87], v[192:195], v[40:43]
    v_mfma_f32_16x16x32_bf16 v[44:47], v[84:87], v[196:199], v[44:47]
    s_waitcnt lgkmcnt(3)
    s_nop 0
    v_mfma_f32_16x16x32_bf16 v[16:19], v[72:75], v[200:203], v[16:19]
    v_mfma_f32_16x16x32_bf16 v[20:23], v[72:75], v[204:207], v[20:23]
    s_waitcnt lgkmcnt(2)
    s_nop 0
    v_mfma_f32_16x16x32_bf16 v[32:35], v[88:91], v[200:203], v[32:35]
    v_mfma_f32_16x16x32_bf16 v[36:39], v[88:91], v[204:207], v[36:39]
    s_waitcnt lgkmcnt(1)
    s_nop 0
    v_mfma_f32_16x16x32_bf16 v[24:27], v[76:79], v[200:203], v[24:27]
    v_mfma_f32_16x16x32_bf16 v[28:31], v[76:79], v[204:207], v[28:31]
    s_waitcnt lgkmcnt(0)
    s_nop 0
    v_mfma_f32_16x16x32_bf16 v[40:43], v[92:95], v[200:203], v[40:43]
    v_mfma_f32_16x16x32_bf16 v[44:47], v[92:95], v[204:207], v[44:47]
    s_add_u32 m0, s60, 0
    s_add_u32 s59, s61, 0
    buffer_load_dwordx4 v5, s[12:15], s59 offen offset:0 lds
    buffer_load_dwordx4 v5, s[12:15], s59 offen offset:1024 lds
    buffer_load_dwordx4 v5, s[12:15], s59 offen offset:2048 lds
    buffer_load_dwordx4 v5, s[12:15], s59 offen offset:3072 lds
    s_add_u32 m0, s60, 4096
    s_add_u32 s59, s61, 4096
    buffer_load_dwordx4 v5, s[12:15], s59 offen offset:0 lds
    buffer_load_dwordx4 v5, s[12:15], s59 offen offset:1024 lds
    buffer_load_dwordx4 v5, s[12:15], s59 offen offset:2048 lds
    buffer_load_dwordx4 v5, s[12:15], s59 offen offset:3072 lds
    s_add_u32 s61, s61, 32768
    s_add_u32 s60, s60, 32768
    s_and_b32 s60, s60, 0x1ffff
    s_waitcnt vmcnt(20)
    s_barrier
    ds_read_b128 v[96:99], v9 offset:20480
    ds_read_b128 v[112:115], v9 offset:53248
    ds_read_b128 v[100:103], v9 offset:20736
    ds_read_b128 v[116:119], v9 offset:53504
    ds_read_b128 v[104:107], v9 offset:22528
    ds_read_b128 v[120:123], v9 offset:55296
    ds_read_b128 v[108:111], v9 offset:22784
    ds_read_b128 v[124:127], v9 offset:55552
    s_waitcnt lgkmcnt(7)
    s_nop 0
    v_mfma_f32_16x16x32_bf16 v[16:19], v[96:99], v[208:211], v[16:19]
    v_mfma_f32_16x16x32_bf16 v[20:23], v[96:99], v[212:215], v[20:23]
    s_waitcnt lgkmcnt(6)
    s_nop 0
    v_mfma_f32_16x16x32_bf16 v[32:35], v[112:115], v[208:211], v[32:35]
    v_mfma_f32_16x16x32_bf16 v[36:39], v[112:115], v[212:215], v[36:39]
    s_waitcnt lgkmcnt(5)
    s_nop 0
    v_mfma_f32_16x16x32_bf16 v[24:27], v[100:103], v[208:211], v[24:27]
    v_mfma_f32_16x16x32_bf16 v[28:31], v[100:103], v[212:215], v[28:31]
    s_waitcnt lgkmcnt(4)
    s_nop 0
    v_mfma_f32_16x16x32_bf16 v[40:43], v[116:119], v[208:211], v[40:43]
    v_mfma_f32_16x16x32_bf16 v[44:47], v[116:119], v[212:215], v[44:47]
    s_waitcnt lgkmcnt(3)
    s_nop 0
    v_mfma_f32_16x16x32_bf16 v[16:19], v[104:107], v[216:219], v[16:19]
    v_mfma_f32_16x16x32_bf16 v[20:23], v[104:107], v[220:223], v[20:23]
    s_waitcnt lgkmcnt(2)
    s_nop 0
    v_mfma_f32_16x16x32_bf16 v[32:35], v[120:123], v[216:219], v[32:35]
    v_mfma_f32_16x16x32_bf16 v[36:39], v[120:123], v[220:223], v[36:39]
    s_waitcnt lgkmcnt(1)
    s_nop 0
    v_mfma_f32_16x16x32_bf16 v[24:27], v[108:111], v[216:219], v[24:27]
    v_mfma_f32_16x16x32_bf16 v[28:31], v[108:111], v[220:223], v[28:31]
    s_waitcnt lgkmcnt(0)
    s_nop 0
    v_mfma_f32_16x16x32_bf16 v[40:43], v[124:127], v[216:219], v[40:43]
    v_mfma_f32_16x16x32_bf16 v[44:47], v[124:127], v[220:223], v[44:47]
    s_add_u32 m0, s60, 0
    s_add_u32 s59, s61, 0
    buffer_load_dwordx4 v5, s[12:15], s59 offen offset:0 lds
    buffer_load_dwordx4 v5, s[12:15], s59 offen offset:1024 lds
    buffer_load_dwordx4 v5, s[12:15], s59 offen offset:2048 lds
    buffer_load_dwordx4 v5, s[12:15], s59 offen offset:3072 lds
    s_add_u32 m0, s60, 4096
    s_add_u32 s59, s61, 4096
    buffer_load_dwordx4 v5, s[12:15], s59 offen offset:0 lds
    buffer_load_dwordx4 v5, s[12:15], s59 offen offset:1024 lds
    buffer_load_dwordx4 v5, s[12:15], s59 offen offset:2048 lds
    buffer_load_dwordx4 v5, s[12:15], s59 offen offset:3072 lds
    s_add_u32 s61, s61, 32768
    s_add_u32 s60, s60, 32768
    s_and_b32 s60, s60, 0x1ffff
    s_waitcnt vmcnt(22)
    s_barrier
    ds_read_b128 v[64:67], v9 offset:24576
    ds_read_b128 v[80:83], v9 offset:57344
    ds_read_b128 v[68:71], v9 offset:24832
    ds_read_b128 v[84:87], v9 offset:57600
    ds_read_b128 v[72:75], v9 offset:26624
    ds_read_b128 v[88:91], v9 offset:59392
    ds_read_b128 v[76:79], v9 offset:26880
    ds_read_b128 v[92:95], v9 offset:59648
    s_waitcnt lgkmcnt(7)
    s_nop 0
    v_mfma_f32_16x16x32_bf16 v[16:19], v[64:67], v[224:227], v[16:19]
    v_mfma_f32_16x16x32_bf16 v[20:23], v[64:67], v[228:231], v[20:23]
    s_waitcnt lgkmcnt(6)
    s_nop 0
    v_mfma_f32_16x16x32_bf16 v[32:35], v[80:83], v[224:227], v[32:35]
    v_mfma_f32_16x16x32_bf16 v[36:39], v[80:83], v[228:231], v[36:39]
    s_waitcnt lgkmcnt(5)
    s_nop 0
    v_mfma_f32_16x16x32_bf16 v[24:27], v[68:71], v[224:227], v[24:27]
    v_mfma_f32_16x16x32_bf16 v[28:31], v[68:71], v[228:231], v[28:31]
    s_waitcnt lgkmcnt(4)
    s_nop 0
    v_mfma_f32_16x16x32_bf16 v[40:43], v[84:87], v[224:227], v[40:43]
    v_mfma_f32_16x16x32_bf16 v[44:47], v[84:87], v[228:231], v[44:47]
    s_waitcnt lgkmcnt(3)
    s_nop 0
    v_mfma_f32_16x16x32_bf16 v[16:19], v[72:75], v[232:235], v[16:19]
    v_mfma_f32_16x16x32_bf16 v[20:23], v[72:75], v[236:239], v[20:23]
    s_waitcnt lgkmcnt(2)
    s_nop 0
    v_mfma_f32_16x16x32_bf16 v[32:35], v[88:91], v[232:235], v[32:35]
    v_mfma_f32_16x16x32_bf16 v[36:39], v[88:91], v[236:239], v[36:39]
    s_waitcnt lgkmcnt(1)
    s_nop 0
    v_mfma_f32_16x16x32_bf16 v[24:27], v[76:79], v[232:235], v[24:27]
    v_mfma_f32_16x16x32_bf16 v[28:31], v[76:79], v[236:239], v[28:31]
    s_waitcnt lgkmcnt(0)
    s_nop 0
    v_mfma_f32_16x16x32_bf16 v[40:43], v[92:95], v[232:235], v[40:43]
    v_mfma_f32_16x16x32_bf16 v[44:47], v[92:95], v[236:239], v[44:47]
    s_waitcnt vmcnt(16)
    s_barrier
    ds_read_b128 v[96:99], v9 offset:28672
    ds_read_b128 v[112:115], v9 offset:61440
    ds_read_b128 v[100:103], v9 offset:28928
    ds_read_b128 v[116:119], v9 offset:61696
    ds_read_b128 v[104:107], v9 offset:30720
    ds_read_b128 v[120:123], v9 offset:63488
    ds_read_b128 v[108:111], v9 offset:30976
    ds_read_b128 v[124:127], v9 offset:63744
    s_waitcnt lgkmcnt(7)
    s_nop 0
    v_mfma_f32_16x16x32_bf16 v[16:19], v[96:99], v[240:243], v[16:19]
    v_mfma_f32_16x16x32_bf16 v[20:23], v[96:99], v[244:247], v[20:23]
    s_waitcnt lgkmcnt(6)
    s_nop 0
    v_mfma_f32_16x16x32_bf16 v[32:35], v[112:115], v[240:243], v[32:35]
    v_mfma_f32_16x16x32_bf16 v[36:39], v[112:115], v[244:247], v[36:39]
    s_waitcnt lgkmcnt(5)
    s_nop 0
    v_mfma_f32_16x16x32_bf16 v[24:27], v[100:103], v[240:243], v[24:27]
    v_mfma_f32_16x16x32_bf16 v[28:31], v[100:103], v[244:247], v[28:31]
    s_waitcnt lgkmcnt(4)
    s_nop 0
    v_mfma_f32_16x16x32_bf16 v[40:43], v[116:119], v[240:243], v[40:43]
    v_mfma_f32_16x16x32_bf16 v[44:47], v[116:119], v[244:247], v[44:47]
    s_waitcnt lgkmcnt(3)
    s_nop 0
    v_mfma_f32_16x16x32_bf16 v[16:19], v[104:107], v[248:251], v[16:19]
    v_mfma_f32_16x16x32_bf16 v[20:23], v[104:107], v[252:255], v[20:23]
    s_waitcnt lgkmcnt(2)
    s_nop 0
    v_mfma_f32_16x16x32_bf16 v[32:35], v[120:123], v[248:251], v[32:35]
    v_mfma_f32_16x16x32_bf16 v[36:39], v[120:123], v[252:255], v[36:39]
    s_waitcnt lgkmcnt(1)
    s_nop 0
    v_mfma_f32_16x16x32_bf16 v[24:27], v[108:111], v[248:251], v[24:27]
    v_mfma_f32_16x16x32_bf16 v[28:31], v[108:111], v[252:255], v[28:31]
    s_waitcnt lgkmcnt(0)
    s_nop 0
    v_mfma_f32_16x16x32_bf16 v[40:43], v[124:127], v[248:251], v[40:43]
    v_mfma_f32_16x16x32_bf16 v[44:47], v[124:127], v[252:255], v[44:47]
    v_add_u32 v7, 0x10000, v9
    s_nop 7
    s_nop 7
    v_mul_f32 v48, v16, v16
    v_mul_f32 v50, v17, v17
    v_fma_f32 v48, v48, s57, v52
    v_fma_f32 v50, v50, s57, v52
    v_mul_f32 v48, v48, v16
    v_mul_f32 v50, v50, v17
    v_exp_f32 v48, v48
    v_exp_f32 v50, v50
    v_mul_f32 v49, v16, v24
    v_mul_f32 v51, v17, v25
    v_add_f32 v48, 1.0, v48
    v_add_f32 v50, 1.0, v50
    v_rcp_f32 v48, v48
    v_rcp_f32 v50, v50
    v_mul_f32 v48, v48, v49
    v_mul_f32 v50, v50, v51
    v_cvt_pk_bf16_f32 v56, v48, v50
    v_mul_f32 v48, v18, v18
    v_mul_f32 v50, v19, v19
    v_fma_f32 v48, v48, s57, v52
    v_fma_f32 v50, v50, s57, v52
    v_mul_f32 v48, v48, v18
    v_mul_f32 v50, v50, v19
    v_exp_f32 v48, v48
    v_exp_f32 v50, v50
    v_mul_f32 v49, v18, v26
    v_mul_f32 v51, v19, v27
    v_add_f32 v48, 1.0, v48
    v_add_f32 v50, 1.0, v50
    v_rcp_f32 v48, v48
    v_rcp_f32 v50, v50
    v_mul_f32 v48, v48, v49
    v_mul_f32 v50, v50, v51
    v_cvt_pk_bf16_f32 v57, v48, v50
    v_mul_f32 v48, v20, v20
    v_mul_f32 v50, v21, v21
    v_fma_f32 v48, v48, s57, v52
    v_fma_f32 v50, v50, s57, v52
    v_mul_f32 v48, v48, v20
    v_mul_f32 v50, v50, v21
    v_exp_f32 v48, v48
    v_exp_f32 v50, v50
    v_mul_f32 v49, v20, v28
    v_mul_f32 v51, v21, v29
    v_add_f32 v48, 1.0, v48
    v_add_f32 v50, 1.0, v50
    v_rcp_f32 v48, v48
    v_rcp_f32 v50, v50
    v_mul_f32 v48, v48, v49
    v_mul_f32 v50, v50, v51
    v_cvt_pk_bf16_f32 v58, v48, v50
    v_mul_f32 v48, v22, v22
    v_mul_f32 v50, v23, v23
    v_fma_f32 v48, v48, s57, v52
    v_fma_f32 v50, v50, s57, v52
    v_mul_f32 v48, v48, v22
    v_mul_f32 v50, v50, v23
    v_exp_f32 v48, v48
    v_exp_f32 v50, v50
    v_mul_f32 v49, v22, v30
    v_mul_f32 v51, v23, v31
    v_add_f32 v48, 1.0, v48
    v_add_f32 v50, 1.0, v50
    v_rcp_f32 v48, v48
    v_rcp_f32 v50, v50
    v_mul_f32 v48, v48, v49
    v_mul_f32 v50, v50, v51
    v_cvt_pk_bf16_f32 v59, v48, v50
    buffer_store_dwordx2 v[56:57], v6, s[16:19], 0 offen sc1
    buffer_store_dwordx2 v[58:59], v6, s[16:19], 0 offen offset:256 sc1
    v_add_u32 v6, 1024, v6
    s_waitcnt vmcnt(8)
    s_barrier
    ds_read_b128 v[64:67], v7 offset:0
    ds_read_b128 v[68:71], v7 offset:256
    ds_read_b128 v[72:75], v7 offset:2048
    ds_read_b128 v[76:79], v7 offset:2304
    ds_read_b128 v[80:83], v7 offset:4096
    ds_read_b128 v[84:87], v7 offset:4352
    ds_read_b128 v[88:91], v7 offset:6144
    ds_read_b128 v[92:95], v7 offset:6400
    s_mov_b32 s63, 2
    s_branch kb_mid
kb_loop:
    s_waitcnt lgkmcnt(4)
    s_nop 0
    v_mfma_f32_16x16x32_bf16 v[32:35], v[64:67], v[128:131], 0
    ds_read_b128 v[96:99], v7 offset:8192
    v_mfma_f32_16x16x32_bf16 v[36:39], v[64:67], v[132:135], 0
    v_mfma_f32_16x16x32_bf16 v[40:43], v[68:71], v[128:131], 0
    ds_read_b128 v[100:103], v7 offset:8448
    v_mfma_f32_16x16x32_bf16 v[44:47], v[68:71], v[132:135], 0
    s_cmp_gt_u32 s63, 4
    s_cselect_b32 s14, 0, 0x380000
    s_nop 0
    v_mfma_f32_16x16x32_bf16 v[32:35], v[72:75], v[136:139], v[32:35]
    ds_read_b128 v[104:107], v7 offset:10240
    s_add_u32 m0, s60, 0
    s_add_u32 s59, s61, 0
    v_mul_f32 v48, v16, v16
    v_mul_f32 v50, v17, v17
    v_mfma_f32_16x16x32_bf16 v[36:39], v[72:75], v[140:143], v[36:39]
    buffer_load_dwordx4 v5, s[12:15], s59 offen offset:0 lds
    v_mfma_f32_16x16x32_bf16 v[40:43], v[76:79], v[136:139], v[40:43]
    ds_read_b128 v[108:111], v7 offset:10496
    v_fma_f32 v48, v48, s57, v52
    v_fma_f32 v50, v50, s57, v52
    v_mfma_f32_16x16x32_bf16 v[44:47], v[76:79], v[140:143], v[44:47]
    v_mul_f32 v48, v48, v16
    v_mul_f32_e64 v50, v50, v17
    s_waitcnt lgkmcnt(4)
    v_mfma_f32_16x16x32_bf16 v[32:35], v[80:83], v[144:147], v[32:35]
    ds_read_b128 v[112:115], v7 offset:12288
    v_exp_f32_e64 v48, v48
    v_mfma_f32_16x16x32_bf16 v[36:39], v[80:83], v[148:151], v[36:39]
    v_exp_f32 v50, v50
    v_mul_f32 v49, v16, v24
    v_mfma_f32_16x16x32_bf16 v[40:43], v[84:87], v[144:147], v[40:43]
    ds_read_b128 v[116:119], v7 offset:12544
    v_mul_f32 v51, v17, v25
    v_add_f32 v48, 1.0, v48
    v_mfma_f32_16x16x32_bf16 v[44:47], v[84:87], v[148:151], v[44:47]
    buffer_load_dwordx4 v5, s[12:15], s59 offen offset:1024 lds
    v_mfma_f32_16x16x32_bf16 v[32:35], v[88:91], v[152:155], v[32:35]
    ds_read_b128 v[120:123], v7 offset:14336
    v_add_f32_e64 v50, 1.0, v50
    v_mfma_f32_16x16x32_bf16 v[36:39], v[88:91], v[156:159], v[36:39]
    v_rcp_f32_e64 v48, v48
    v_mfma_f32_16x16x32_bf16 v[40:43], v[92:95], v[152:155], v[40:43]
    ds_read_b128 v[124:127], v7 offset:14592
    v_rcp_f32_e64 v50, v50
    v_mfma_f32_16x16x32_bf16 v[44:47], v[92:95], v[156:159], v[44:47]
    v_mul_f32 v48, v48, v49
    v_mul_f32 v50, v50, v51
    v_cvt_pk_bf16_f32 v56, v48, v50
    s_waitcnt lgkmcnt(4)
    s_nop 0
    v_mfma_f32_16x16x32_bf16 v[32:35], v[96:99], v[160:163], v[32:35]
    ds_read_b128 v[64:67], v7 offset:16384
    v_mul_f32 v48, v18, v18
    v_mul_f32 v50, v19, v19
    v_mfma_f32_16x16x32_bf16 v[36:39], v[96:99], v[164:167], v[36:39]
    buffer_load_dwordx4 v5, s[12:15], s59 offen offset:2048 lds
    v_mfma_f32_16x16x32_bf16 v[40:43], v[100:103], v[160:163], v[40:43]
    ds_read_b128 v[68:71], v7 offset:16640
    v_fma_f32 v48, v48, s57, v52
    v_fma_f32 v50, v50, s57, v52
    v_mfma_f32_16x16x32_bf16 v[44:47], v[100:103], v[164:167], v[44:47]
    v_mul_f32 v48, v48, v18
    v_mul_f32 v50, v50, v19
    v_mfma_f32_16x16x32_bf16 v[32:35], v[104:107], v[168:171], v[32:35]
    ds_read_b128 v[72:75], v7 offset:18432
    v_exp_f32_e64 v48, v48
    v_mfma_f32_16x16x32_bf16 v[36:39], v[104:107], v[172:175], v[36:39]
    v_exp_f32 v50, v50
    v_mul_f32 v49, v18, v26
    v_mfma_f32_16x16x32_bf16 v[40:43], v[108:111], v[168:171], v[40:43]
    ds_read_b128 v[76:79], v7 offset:18688
    v_mul_f32 v51, v19, v27
    v_add_f32 v48, 1.0, v48
    v_mfma_f32_16x16x32_bf16 v[44:47], v[108:111], v[172:175], v[44:47]
    buffer_load_dwordx4 v5, s[12:15], s59 offen offset:3072 lds
    s_waitcnt lgkmcnt(4)
    s_nop 0
    v_mfma_f32_16x16x32_bf16 v[32:35], v[112:115], v[176:179], v[32:35]
    ds_read_b128 v[80:83], v7 offset:20480
    v_add_f32_e64 v50, 1.0, v50
    v_mfma_f32_16x16x32_bf16 v[36:39], v[112:115], v[180:183], v[36:39]
    v_rcp_f32_e64 v48, v48
    v_mfma_f32_16x16x32_bf16 v[40:43], v[116:119], v[176:179], v[40:43]
    ds_read_b128 v[84:87], v7 offset:20736
    v_rcp_f32_e64 v50, v50
    v_mfma_f32_16x16x32_bf16 v[44:47], v[116:119], v[180:183], v[44:47]
    v_mul_f32 v48, v48, v49
    v_mul_f32 v50, v50, v51
    v_cvt_pk_bf16_f32 v57, v48, v50
    v_mfma_f32_16x16x32_bf16 v[32:35], v[120:123], v[184:187], v[32:35]
    ds_read_b128 v[88:91], v7 offset:22528
    s_add_u32 m0, s60, 4096
    s_add_u32 s59, s61, 4096
    v_mul_f32 v48, v20, v20
    v_mul_f32 v50, v21, v21
    v_mfma_f32_16x16x32_bf16 v[36:39], v[120:123], v[188:191], v[36:39]
    buffer_load_dwordx4 v5, s[12:15], s59 offen offset:0 lds
    v_mfma_f32_16x16x32_bf16 v[40:43], v[124:127], v[184:187], v[40:43]
    ds_read_b128 v[92:95], v7 offset:22784
    v_fma_f32 v48, v48, s57, v52
    v_fma_f32 v50, v50, s57, v52
    v_mfma_f32_16x16x32_bf16 v[44:47], v[124:127], v[188:191], v[44:47]
    v_mul_f32 v48, v48, v20
    v_mul_f32_e64 v50, v50, v21
    s_waitcnt lgkmcnt(4)
    v_mfma_f32_16x16x32_bf16 v[32:35], v[64:67], v[192:195], v[32:35]
    ds_read_b128 v[96:99], v7 offset:24576
    v_exp_f32_e64 v48, v48
    v_mfma_f32_16x16x32_bf16 v[36:39], v[64:67], v[196:199], v[36:39]
    v_exp_f32 v50, v50
    v_mul_f32 v49, v20, v28
    v_mfma_f32_16x16x32_bf16 v[40:43], v[68:71], v[192:195], v[40:43]
    ds_read_b128 v[100:103], v7 offset:24832
    v_mul_f32 v51, v21, v29
    v_add_f32 v48, 1.0, v48
    v_mfma_f32_16x16x32_bf16 v[44:47], v[68:71], v[196:199], v[44:47]
    buffer_load_dwordx4 v5, s[12:15], s59 offen offset:1024 lds
    v_mfma_f32_16x16x32_bf16 v[32:35], v[72:75], v[200:203], v[32:35]
    ds_read_b128 v[104:107], v7 offset:26624
    v_add_f32_e64 v50, 1.0, v50
    v_mfma_f32_16x16x32_bf16 v[36:39], v[72:75], v[204:207], v[36:39]
    v_rcp_f32_e64 v48, v48
    v_mfma_f32_16x16x32_bf16 v[40:43], v[76:79], v[200:203], v[40:43]
    ds_read_b128 v[108:111], v7 offset:26880
    v_rcp_f32_e64 v50, v50
    v_mfma_f32_16x16x32_bf16 v[44:47], v[76:79], v[204:207], v[44:47]
    v_mul_f32 v48, v48, v49
    v_mul_f32 v50, v50, v51
    v_cvt_pk_bf16_f32 v58, v48, v50
    s_waitcnt lgkmcnt(4)
    s_nop 0
    v_mfma_f32_16x16x32_bf16 v[32:35], v[80:83], v[208:211], v[32:35]
    ds_read_b128 v[112:115], v7 offset:28672
    v_mul_f32 v48, v22, v22
    v_mul_f32 v50, v23, v23
    v_mfma_f32_16x16x32_bf16 v[36:39], v[80:83], v[212:215], v[36:39]
    buffer_load_dwordx4 v5, s[12:15], s59 offen offset:2048 lds
    v_add_u32 v8, 0x8000, v7
    v_and_b32 v8, 0x1ffff, v8
    v_mfma_f32_16x16x32_bf16 v[40:43], v[84:87], v[208:211], v[40:43]
    ds_read_b128 v[116:119], v7 offset:28928
    v_fma_f32 v48, v48, s57, v52
    v_fma_f32 v50, v50, s57, v52
    v_mfma_f32_16x16x32_bf16 v[44:47], v[84:87], v[212:215], v[44:47]
    v_mul_f32 v48, v48, v22
    v_mul_f32 v50, v50, v23
    v_mfma_f32_16x16x32_bf16 v[32:35], v[88:91], v[216:219], v[32:35]
    ds_read_b128 v[120:123], v7 offset:30720
    v_exp_f32_e64 v48, v48
    v_mfma_f32_16x16x32_bf16 v[36:39], v[88:91], v[220:223], v[36:39]
    s_waitcnt vmcnt(7)
    s_barrier
    v_mfma_f32_16x16x32_bf16 v[40:43], v[92:95], v[216:219], v[40:43]
    ds_read_b128 v[124:127], v7 offset:30976
    v_exp_f32_e64 v50, v50
    v_mfma_f32_16x16x32_bf16 v[44:47], v[92:95], v[220:223], v[44:47]
    v_mul_f32 v49, v22, v30
    v_mul_f32 v51, v23, v31
    v_add_f32 v48, 1.0, v48
    s_waitcnt lgkmcnt(4)
    v_mfma_f32_16x16x32_bf16 v[32:35], v[96:99], v[224:227], v[32:35]
    ds_read_b128 v[64:67], v8 offset:0
    v_add_f32_e64 v50, 1.0, v50
    v_mfma_f32_16x16x32_bf16 v[36:39], v[96:99], v[228:231], v[36:39]
    buffer_load_dwordx4 v5, s[12:15], s59 offen offset:3072 lds
    s_add_u32 s61, s61, 32768
    s_add_u32 s60, s60, 32768
    s_and_b32 s60, s60, 0x1ffff
    v_mfma_f32_16x16x32_bf16 v[40:43], v[100:103], v[224:227], v[40:43]
    ds_read_b128 v[68:71], v8 offset:256
    v_rcp_f32_e64 v48, v48
    v_mfma_f32_16x16x32_bf16 v[44:47], v[100:103], v[228:231], v[44:47]
    v_rcp_f32 v50, v50
    v_mul_f32 v48, v48, v49
    v_mfma_f32_16x16x32_bf16 v[32:35], v[104:107], v[232:235], v[32:35]
    ds_read_b128 v[72:75], v8 offset:2048
    v_mul_f32_e64 v50, v50, v51
    v_cvt_pk_bf16_f32 v59, v48, v50
    v_mfma_f32_16x16x32_bf16 v[36:39], v[104:107], v[236:239], v[36:39]
    buffer_store_dwordx2 v[56:57], v6, s[16:19], 0 offen sc1
    buffer_store_dwordx2 v[58:59], v6, s[16:19], 0 offen offset:256 sc1
    v_add_u32 v6, 1024, v6
    v_mfma_f32_16x16x32_bf16 v[40:43], v[108:111], v[232:235], v[40:43]
    ds_read_b128 v[76:79], v8 offset:2304
    v_mfma_f32_16x16x32_bf16 v[44:47], v[108:111], v[236:239], v[44:47]
    s_waitcnt lgkmcnt(4)
    s_nop 0
    v_mfma_f32_16x16x32_bf16 v[32:35], v[112:115], v[240:243], v[32:35]
    ds_read_b128 v[80:83], v8 offset:4096
    v_mfma_f32_16x16x32_bf16 v[36:39], v[112:115], v[244:247], v[36:39]
    v_mfma_f32_16x16x32_bf16 v[40:43], v[116:119], v[240:243], v[40:43]
    ds_read_b128 v[84:87], v8 offset:4352
    v_mfma_f32_16x16x32_bf16 v[44:47], v[116:119], v[244:247], v[44:47]
    v_mfma_f32_16x16x32_bf16 v[32:35], v[120:123], v[248:251], v[32:35]
    ds_read_b128 v[88:91], v8 offset:6144
    v_mfma_f32_16x16x32_bf16 v[36:39], v[120:123], v[252:255], v[36:39]
    v_mfma_f32_16x16x32_bf16 v[40:43], v[124:127], v[248:251], v[40:43]
    ds_read_b128 v[92:95], v8 offset:6400
    v_mfma_f32_16x16x32_bf16 v[44:47], v[124:127], v[252:255], v[44:47]
    v_mov_b32_e64 v7, v8
    s_add_u32 s63, s63, 1
kb_mid:
    s_waitcnt lgkmcnt(4)
    v_mfma_f32_16x16x32_bf16 v[16:19], v[64:67], v[128:131], 0
    ds_read_b128 v[96:99], v7 offset:8192
    v_mfma_f32_16x16x32_bf16 v[20:23], v[64:67], v[132:135], 0
    v_mfma_f32_16x16x32_bf16 v[24:27], v[68:71], v[128:131], 0
    ds_read_b128 v[100:103], v7 offset:8448
    v_mfma_f32_16x16x32_bf16 v[28:31], v[68:71], v[132:135], 0
    s_cmp_gt_u32 s63, 4
    s_cselect_b32 s14, 0, 0x380000
    s_nop 0
    v_mfma_f32_16x16x32_bf16 v[16:19], v[72:75], v[136:139], v[16:19]
    ds_read_b128 v[104:107], v7 offset:10240
    s_add_u32 m0, s60, 0
    s_add_u32 s59, s61, 0
    v_mul_f32 v48, v32, v32
    v_mul_f32 v50, v33, v33
    v_mfma_f32_16x16x32_bf16 v[20:23], v[72:75], v[140:143], v[20:23]
    buffer_load_dwordx4 v5, s[12:15], s59 offen offset:0 lds
    v_mfma_f32_16x16x32_bf16 v[24:27], v[76:79], v[136:139], v[24:27]
    ds_read_b128 v[108:111], v7 offset:10496
    v_fma_f32 v48, v48, s57, v52
    v_fma_f32 v50, v50, s57, v52
    v_mfma_f32_16x16x32_bf16 v[28:31], v[76:79], v[140:143], v[28:31]
    v_mul_f32 v48, v48, v32
    v_mul_f32_e64 v50, v50, v33
    s_waitcnt lgkmcnt(4)
    v_mfma_f32_16x16x32_bf16 v[16:19], v[80:83], v[144:147], v[16:19]
    ds_read_b128 v[112:115], v7 offset:12288
    v_exp_f32_e64 v48, v48
    v_mfma_f32_16x16x32_bf16 v[20:23], v[80:83], v[148:151], v[20:23]
    v_exp_f32 v50, v50
    v_mul_f32 v49, v32, v40
    v_mfma_f32_16x16x32_bf16 v[24:27], v[84:87], v[144:147], v[24:27]
    ds_read_b128 v[116:119], v7 offset:12544
    v_mul_f32 v51, v33, v41
    v_add_f32 v48, 1.0, v48
    v_mfma_f32_16x16x32_bf16 v[28:31], v[84:87], v[148:151], v[28:31]
    buffer_load_dwordx4 v5, s[12:15], s59 offen offset:1024 lds
    v_mfma_f32_16x16x32_bf16 v[16:19], v[88:91], v[152:155], v[16:19]
    ds_read_b128 v[120:123], v7 offset:14336
    v_add_f32_e64 v50, 1.0, v50
    v_mfma_f32_16x16x32_bf16 v[20:23], v[88:91], v[156:159], v[20:23]
    v_rcp_f32_e64 v48, v48
    v_mfma_f32_16x16x32_bf16 v[24:27], v[92:95], v[152:155], v[24:27]
    ds_read_b128 v[124:127], v7 offset:14592
    v_rcp_f32_e64 v50, v50
    v_mfma_f32_16x16x32_bf16 v[28:31], v[92:95], v[156:159], v[28:31]
    v_mul_f32 v48, v48, v49
    v_mul_f32 v50, v50, v51
    v_cvt_pk_bf16_f32 v56, v48, v50
    s_waitcnt lgkmcnt(4)
    s_nop 0
    v_mfma_f32_16x16x32_bf16 v[16:19], v[96:99], v[160:163], v[16:19]
    ds_read_b128 v[64:67], v7 offset:16384
    v_mul_f32 v48, v34, v34
    v_mul_f32 v50, v35, v35
    v_mfma_f32_16x16x32_bf16 v[20:23], v[96:99], v[164:167], v[20:23]
    buffer_load_dwordx4 v5, s[12:15], s59 offen offset:2048 lds
    v_mfma_f32_16x16x32_bf16 v[24:27], v[100:103], v[160:163], v[24:27]
    ds_read_b128 v[68:71], v7 offset:16640
    v_fma_f32 v48, v48, s57, v52
    v_fma_f32 v50, v50, s57, v52
    v_mfma_f32_16x16x32_bf16 v[28:31], v[100:103], v[164:167], v[28:31]
    v_mul_f32 v48, v48, v34
    v_mul_f32 v50, v50, v35
    v_mfma_f32_16x16x32_bf16 v[16:19], v[104:107], v[168:171], v[16:19]
    ds_read_b128 v[72:75], v7 offset:18432
    v_exp_f32_e64 v48, v48
    v_mfma_f32_16x16x32_bf16 v[20:23], v[104:107], v[172:175], v[20:23]
    v_exp_f32 v50, v50
    v_mul_f32 v49, v34, v42
    v_mfma_f32_16x16x32_bf16 v[24:27], v[108:111], v[168:171], v[24:27]
    ds_read_b128 v[76:79], v7 offset:18688
    v_mul_f32 v51, v35, v43
    v_add_f32 v48, 1.0, v48
    v_mfma_f32_16x16x32_bf16 v[28:31], v[108:111], v[172:175], v[28:31]
    buffer_load_dwordx4 v5, s[12:15], s59 offen offset:3072 lds
    s_waitcnt lgkmcnt(4)
    s_nop 0
    v_mfma_f32_16x16x32_bf16 v[16:19], v[112:115], v[176:179], v[16:19]
    ds_read_b128 v[80:83], v7 offset:20480
    v_add_f32_e64 v50, 1.0, v50
    v_mfma_f32_16x16x32_bf16 v[20:23], v[112:115], v[180:183], v[20:23]
    v_rcp_f32_e64 v48, v48
    v_mfma_f32_16x16x32_bf16 v[24:27], v[116:119], v[176:179], v[24:27]
    ds_read_b128 v[84:87], v7 offset:20736
    v_rcp_f32_e64 v50, v50
    v_mfma_f32_16x16x32_bf16 v[28:31], v[116:119], v[180:183], v[28:31]
    v_mul_f32 v48, v48, v49
    v_mul_f32 v50, v50, v51
    v_cvt_pk_bf16_f32 v57, v48, v50
    v_mfma_f32_16x16x32_bf16 v[16:19], v[120:123], v[184:187], v[16:19]
    ds_read_b128 v[88:91], v7 offset:22528
    s_add_u32 m0, s60, 4096
    s_add_u32 s59, s61, 4096
    v_mul_f32 v48, v36, v36
    v_mul_f32 v50, v37, v37
    v_mfma_f32_16x16x32_bf16 v[20:23], v[120:123], v[188:191], v[20:23]
    buffer_load_dwordx4 v5, s[12:15], s59 offen offset:0 lds
    v_mfma_f32_16x16x32_bf16 v[24:27], v[124:127], v[184:187], v[24:27]
    ds_read_b128 v[92:95], v7 offset:22784
    v_fma_f32 v48, v48, s57, v52
    v_fma_f32 v50, v50, s57, v52
    v_mfma_f32_16x16x32_bf16 v[28:31], v[124:127], v[188:191], v[28:31]
    v_mul_f32 v48, v48, v36
    v_mul_f32_e64 v50, v50, v37
    s_waitcnt lgkmcnt(4)
    v_mfma_f32_16x16x32_bf16 v[16:19], v[64:67], v[192:195], v[16:19]
    ds_read_b128 v[96:99], v7 offset:24576
    v_exp_f32_e64 v48, v48
    v_mfma_f32_16x16x32_bf16 v[20:23], v[64:67], v[196:199], v[20:23]
    v_exp_f32 v50, v50
    v_mul_f32 v49, v36, v44
    v_mfma_f32_16x16x32_bf16 v[24:27], v[68:71], v[192:195], v[24:27]
    ds_read_b128 v[100:103], v7 offset:24832
    v_mul_f32 v51, v37, v45
    v_add_f32 v48, 1.0, v48
    v_mfma_f32_16x16x32_bf16 v[28:31], v[68:71], v[196:199], v[28:31]
    buffer_load_dwordx4 v5, s[12:15], s59 offen offset:1024 lds
    v_mfma_f32_16x16x32_bf16 v[16:19], v[72:75], v[200:203], v[16:19]
    ds_read_b128 v[104:107], v7 offset:26624
    v_add_f32_e64 v50, 1.0, v50
    v_mfma_f32_16x16x32_bf16 v[20:23], v[72:75], v[204:207], v[20:23]
    v_rcp_f32_e64 v48, v48
    v_mfma_f32_16x16x32_bf16 v[24:27], v[76:79], v[200:203], v[24:27]
    ds_read_b128 v[108:111], v7 offset:26880
    v_rcp_f32_e64 v50, v50
    v_mfma_f32_16x16x32_bf16 v[28:31], v[76:79], v[204:207], v[28:31]
    v_mul_f32 v48, v48, v49
    v_mul_f32 v50, v50, v51
    v_cvt_pk_bf16_f32 v58, v48, v50
    s_waitcnt lgkmcnt(4)
    s_nop 0
    v_mfma_f32_16x16x32_bf16 v[16:19], v[80:83], v[208:211], v[16:19]
    ds_read_b128 v[112:115], v7 offset:28672
    v_mul_f32 v48, v38, v38
    v_mul_f32 v50, v39, v39
    v_mfma_f32_16x16x32_bf16 v[20:23], v[80:83], v[212:215], v[20:23]
    buffer_load_dwordx4 v5, s[12:15], s59 offen offset:2048 lds
    v_add_u32 v8, 0x8000, v7
    v_and_b32 v8, 0x1ffff, v8
    v_mfma_f32_16x16x32_bf16 v[24:27], v[84:87], v[208:211], v[24:27]
    ds_read_b128 v[116:119], v7 offset:28928
    v_fma_f32 v48, v48, s57, v52
    v_fma_f32 v50, v50, s57, v52
    v_mfma_f32_16x16x32_bf16 v[28:31], v[84:87], v[212:215], v[28:31]
    v_mul_f32 v48, v48, v38
    v_mul_f32 v50, v50, v39
    v_mfma_f32_16x16x32_bf16 v[16:19], v[88:91], v[216:219], v[16:19]
    ds_read_b128 v[120:123], v7 offset:30720
    v_exp_f32_e64 v48, v48
    v_mfma_f32_16x16x32_bf16 v[20:23], v[88:91], v[220:223], v[20:23]
    s_waitcnt vmcnt(7)
    s_barrier
    v_mfma_f32_16x16x32_bf16 v[24:27], v[92:95], v[216:219], v[24:27]
    ds_read_b128 v[124:127], v7 offset:30976
    v_exp_f32_e64 v50, v50
    v_mfma_f32_16x16x32_bf16 v[28:31], v[92:95], v[220:223], v[28:31]
    v_mul_f32 v49, v38, v46
    v_mul_f32 v51, v39, v47
    v_add_f32 v48, 1.0, v48
    s_waitcnt lgkmcnt(4)
    v_mfma_f32_16x16x32_bf16 v[16:19], v[96:99], v[224:227], v[16:19]
    ds_read_b128 v[64:67], v8 offset:0
    v_add_f32_e64 v50, 1.0, v50
    v_mfma_f32_16x16x32_bf16 v[20:23], v[96:99], v[228:231], v[20:23]
    buffer_load_dwordx4 v5, s[12:15], s59 offen offset:3072 lds
    s_add_u32 s61, s61, 32768
    s_add_u32 s60, s60, 32768
    s_and_b32 s60, s60, 0x1ffff
    v_mfma_f32_16x16x32_bf16 v[24:27], v[100:103], v[224:227], v[24:27]
    ds_read_b128 v[68:71], v8 offset:256
    v_rcp_f32_e64 v48, v48
    v_mfma_f32_16x16x32_bf16 v[28:31], v[100:103], v[228:231], v[28:31]
    v_rcp_f32 v50, v50
    v_mul_f32 v48, v48, v49
    v_mfma_f32_16x16x32_bf16 v[16:19], v[104:107], v[232:235], v[16:19]
    ds_read_b128 v[72:75], v8 offset:2048
    v_mul_f32_e64 v50, v50, v51
    v_cvt_pk_bf16_f32 v59, v48, v50
    v_mfma_f32_16x16x32_bf16 v[20:23], v[104:107], v[236:239], v[20:23]
    buffer_store_dwordx2 v[56:57], v6, s[16:19], 0 offen sc1
    buffer_store_dwordx2 v[58:59], v6, s[16:19], 0 offen offset:256 sc1
    v_add_u32 v6, 1024, v6
    v_mfma_f32_16x16x32_bf16 v[24:27], v[108:111], v[232:235], v[24:27]
    ds_read_b128 v[76:79], v8 offset:2304
    v_mfma_f32_16x16x32_bf16 v[28:31], v[108:111], v[236:239], v[28:31]
    s_waitcnt lgkmcnt(4)
    s_nop 0
    v_mfma_f32_16x16x32_bf16 v[16:19], v[112:115], v[240:243], v[16:19]
    ds_read_b128 v[80:83], v8 offset:4096
    v_mfma_f32_16x16x32_bf16 v[20:23], v[112:115], v[244:247], v[20:23]
    v_mfma_f32_16x16x32_bf16 v[24:27], v[116:119], v[240:243], v[24:27]
    ds_read_b128 v[84:87], v8 offset:4352
    v_mfma_f32_16x16x32_bf16 v[28:31], v[116:119], v[244:247], v[28:31]
    v_mfma_f32_16x16x32_bf16 v[16:19], v[120:123], v[248:251], v[16:19]
    ds_read_b128 v[88:91], v8 offset:6144
    v_mfma_f32_16x16x32_bf16 v[20:23], v[120:123], v[252:255], v[20:23]
    v_mfma_f32_16x16x32_bf16 v[24:27], v[124:127], v[248:251], v[24:27]
    ds_read_b128 v[92:95], v8 offset:6400
    v_mfma_f32_16x16x32_bf16 v[28:31], v[124:127], v[252:255], v[28:31]
    v_mov_b32 v7, v8
    s_add_u32 s63, s63, 1
    s_cmp_lt_u32 s63, 7
    s_cbranch_scc1 kb_loop
    s_nop 7
    s_nop 7
    v_mul_f32 v48, v16, v16
    v_mul_f32 v50, v17, v17
    v_fma_f32 v48, v48, s57, v52
    v_fma_f32 v50, v50, s57, v52
    v_mul_f32 v48, v48, v16
    v_mul_f32 v50, v50, v17
    v_exp_f32 v48, v48
    v_exp_f32 v50, v50
    v_mul_f32 v49, v16, v24
    v_mul_f32 v51, v17, v25
    v_add_f32 v48, 1.0, v48
    v_add_f32 v50, 1.0, v50
    v_rcp_f32 v48, v48
    v_rcp_f32 v50, v50
    v_mul_f32 v48, v48, v49
    v_mul_f32 v50, v50, v51
    v_cvt_pk_bf16_f32 v56, v48, v50
    v_mul_f32 v48, v18, v18
    v_mul_f32 v50, v19, v19
    v_fma_f32 v48, v48, s57, v52
    v_fma_f32 v50, v50, s57, v52
    v_mul_f32 v48, v48, v18
    v_mul_f32 v50, v50, v19
    v_exp_f32 v48, v48
    v_exp_f32 v50, v50
    v_mul_f32 v49, v18, v26
    v_mul_f32 v51, v19, v27
    v_add_f32 v48, 1.0, v48
    v_add_f32 v50, 1.0, v50
    v_rcp_f32 v48, v48
    v_rcp_f32 v50, v50
    v_mul_f32 v48, v48, v49
    v_mul_f32 v50, v50, v51
    v_cvt_pk_bf16_f32 v57, v48, v50
    v_mul_f32 v48, v20, v20
    v_mul_f32 v50, v21, v21
    v_fma_f32 v48, v48, s57, v52
    v_fma_f32 v50, v50, s57, v52
    v_mul_f32 v48, v48, v20
    v_mul_f32 v50, v50, v21
    v_exp_f32 v48, v48
    v_exp_f32 v50, v50
    v_mul_f32 v49, v20, v28
    v_mul_f32 v51, v21, v29
    v_add_f32 v48, 1.0, v48
    v_add_f32 v50, 1.0, v50
    v_rcp_f32 v48, v48
    v_rcp_f32 v50, v50
    v_mul_f32 v48, v48, v49
    v_mul_f32 v50, v50, v51
    v_cvt_pk_bf16_f32 v58, v48, v50
    v_mul_f32 v48, v22, v22
    v_mul_f32 v50, v23, v23
    v_fma_f32 v48, v48, s57, v52
    v_fma_f32 v50, v50, s57, v52
    v_mul_f32 v48, v48, v22
    v_mul_f32 v50, v50, v23
    v_exp_f32 v48, v48
    v_exp_f32 v50, v50
    v_mul_f32 v49, v22, v30
    v_mul_f32 v51, v23, v31
    v_add_f32 v48, 1.0, v48
    v_add_f32 v50, 1.0, v50
    v_rcp_f32 v48, v48
    v_rcp_f32 v50, v50
    v_mul_f32 v48, v48, v49
    v_mul_f32 v50, v50, v51
    v_cvt_pk_bf16_f32 v59, v48, v50
    buffer_store_dwordx2 v[56:57], v6, s[16:19], 0 offen sc1
    buffer_store_dwordx2 v[58:59], v6, s[16:19], 0 offen offset:256 sc1
    v_add_u32 v6, 1024, v6
    s_waitcnt lgkmcnt(0) vmcnt(0)
kb_exit:
    s_endpgm
.p2align 8
.globl kc0_kernel
.type kc0_kernel,@function
kc0_kernel:
    s_mov_b32 s3, 0
    s_branch kc_body
.p2align 8
.globl kc1_kernel
.type kc1_kernel,@function
kc1_kernel:
    s_mov_b32 s3, 1
    s_branch kc_body
kc_body:
    s_load_dwordx16 s[32:47], s[0:1], 0
    s_load_dwordx8 s[48:55], s[0:1], 64
    v_and_b32 v1, 63, v0
    v_lshrrev_b32 v4, 6, v0
    v_and_b32_e64 v2, 15, v0
    v_bfe_u32 v3, v0, 4, 2
    v_readfirstlane_b32 s4, v4
    s_cmp_ge_u32 s2, 256
    s_cbranch_scc1 kc_exit
    s_and_b32 s5, s2, 7
    s_lshl_b32 s5, s5, 2
    s_lshr_b32 s6, s2, 6
    s_add_u32 s5, s5, s6
    s_bfe_u32 s6, s2, 0x30003
    s_waitcnt lgkmcnt(0)
    s_add_u32 s8, s54, 0x1400000
    s_addc_u32 s9, s55, 0
    s_mov_b32 s10, 0x1c0000
    s_mov_b32 s11, 0x00020000
    s_add_u32 s12, s54, 0x600000
    s_addc_u32 s13, s55, 0
    s_mov_b32 s14, 0x700000
    s_mov_b32 s15, 0x00020000
    s_add_u32 s16, s54, 0x200000
    s_addc_u32 s17, s55, 0
    s_mov_b32 s18, 0x200000
    s_mov_b32 s19, 0x00020000
    s_add_u32 s24, s54, 0xe00000
    s_addc_u32 s25, s55, 0
    s_cmp_eq_u32 s3, 0
    s_cselect_b32 s20, s24, s50
    s_cselect_b32 s21, s25, s51
    s_mov_b32 s22, 0x200000
    s_mov_b32 s23, 0x00020000
    s_and_b32 s7, s4, 1
    s_lshr_b32 s28, s4, 1
    s_lshl_b32 s29, s6, 1
    s_add_u32 s29, s29, s7
    s_lshl_b32 s30, s5, 1
    s_add_u32 s30, s30, s28
    s_xor_b32 s31, s29, 1
    s_xor_b32 s56, s30, 1
    s_mul_i32 s57, s4, 28
    s_mul_i32 s58, s29, 112
    s_add_u32 s58, s58, s57
    s_lshl_b32 s58, s58, 10
    v_lshl_add_u32 v4, v1, 4, s58
    s_mul_i32 s58, s31, 112
    s_add_u32 s58, s58, s57
    s_lshl_b32 s58, s58, 10
    v_lshl_add_u32 v5, v1, 4, s58
    s_mul_i32 s58, s30, 112
    s_add_u32 s58, s58, s57
    s_lshl_b32 s58, s58, 10
    v_lshl_add_u32 v6, v1, 4, s58
    s_mul_i32 s58, s56, 112
    s_add_u32 s58, s58, s57
    s_lshl_b32 s58, s58, 10
    v_lshl_add_u32 v7, v1, 4, s58
    v_and_b32 v8, 31, v1
    v_lshlrev_b32 v8, 6, v8
    v_add_u32 v8, s30, v8
    v_lshlrev_b32 v8, 10, v8
    v_lshrrev_b32 v9, 5, v1
    v_lshl_add_u32 v8, v9, 3, v8
    s_lshl_b32 s58, s29, 6
    v_add_u32 v8, s58, v8
    v_and_b32 v10, 31, v1
    v_lshlrev_b32 v10, 4, v10
    v_lshl_add_u32 v10, v9, 3, v10
    s_lshl_b32 s58, s30, 15
    s_lshl_b32 s59, s29, 11
    s_add_u32 s58, s58, s59
    v_add_u32 v10, s58, v10
    v_lshl_add_u32 v8, v9, 3, v8
    buffer_load_dwordx2 v[80:81], v10, s[16:19], 0 offen offset:0
    buffer_load_dwordx2 v[82:83], v10, s[16:19], 0 offen offset:512
    buffer_load_dwordx2 v[84:85], v10, s[16:19], 0 offen offset:1024
    buffer_load_dwordx2 v[86:87], v10, s[16:19], 0 offen offset:1536
    s_mov_b32 s58, 0
    s_nop 0
    buffer_load_dwordx4 v[96:99], v4, s[8:11], s58 offen offset:0
    buffer_load_dwordx4 v[100:103], v5, s[8:11], s58 offen offset:0
    buffer_load_dwordx4 v[104:107], v6, s[12:15], s58 offen offset:0
    buffer_load_dwordx4 v[108:111], v7, s[12:15], s58 offen offset:0
    buffer_load_dwordx4 v[112:115], v4, s[8:11], s58 offen offset:1024
    buffer_load_dwordx4 v[116:119], v5, s[8:11], s58 offen offset:1024
    buffer_load_dwordx4 v[120:123], v6, s[12:15], s58 offen offset:1024
    buffer_load_dwordx4 v[124:127], v7, s[12:15], s58 offen offset:1024
    buffer_load_dwordx4 v[128:131], v4, s[8:11], s58 offen offset:2048
    buffer_load_dwordx4 v[132:135], v5, s[8:11], s58 offen offset:2048
    buffer_load_dwordx4 v[136:139], v6, s[12:15], s58 offen offset:2048
    buffer_load_dwordx4 v[140:143], v7, s[12:15], s58 offen offset:2048
    buffer_load_dwordx4 v[144:147], v4, s[8:11], s58 offen offset:3072
    buffer_load_dwordx4 v[148:151], v5, s[8:11], s58 offen offset:3072
    buffer_load_dwordx4 v[152:155], v6, s[12:15], s58 offen offset:3072
    buffer_load_dwordx4 v[156:159], v7, s[12:15], s58 offen offset:3072
    s_mov_b32 s58, 4096
    buffer_load_dwordx4 v[160:163], v4, s[8:11], s58 offen offset:0
    buffer_load_dwordx4 v[164:167], v5, s[8:11], s58 offen offset:0
    buffer_load_dwordx4 v[168:171], v6, s[12:15], s58 offen offset:0
    buffer_load_dwordx4 v[172:175], v7, s[12:15], s58 offen offset:0
    buffer_load_dwordx4 v[176:179], v4, s[8:11], s58 offen offset:1024
    buffer_load_dwordx4 v[180:183], v5, s[8:11], s58 offen offset:1024
    buffer_load_dwordx4 v[184:187], v6, s[12:15], s58 offen offset:1024
    buffer_load_dwordx4 v[188:191], v7, s[12:15], s58 offen offset:1024
    buffer_load_dwordx4 v[192:195], v4, s[8:11], s58 offen offset:2048
    buffer_load_dwordx4 v[196:199], v5, s[8:11], s58 offen offset:2048
    buffer_load_dwordx4 v[200:203], v6, s[12:15], s58 offen offset:2048
    buffer_load_dwordx4 v[204:207], v7, s[12:15], s58 offen offset:2048
    v_mov_b32 v16, 0
    v_mov_b32 v17, 0
    v_mov_b32 v18, 0
    v_mov_b32 v19, 0
    v_mov_b32 v20, 0
    v_mov_b32 v21, 0
    v_mov_b32 v22, 0
    v_mov_b32 v23, 0
    v_mov_b32 v24, 0
    v_mov_b32 v25, 0
    v_mov_b32 v26, 0
    v_mov_b32 v27, 0
    v_mov_b32 v28, 0
    v_mov_b32 v29, 0
    v_mov_b32 v30, 0
    v_mov_b32 v31, 0
    v_mov_b32 v32, 0
    v_mov_b32 v33, 0
    v_mov_b32 v34, 0
    v_mov_b32 v35, 0
    v_mov_b32 v36, 0
    v_mov_b32 v37, 0
    v_mov_b32 v38, 0
    v_mov_b32 v39, 0
    v_mov_b32 v40, 0
    v_mov_b32 v41, 0
    v_mov_b32 v42, 0
    v_mov_b32 v43, 0
    v_mov_b32 v44, 0
    v_mov_b32 v45, 0
    v_mov_b32 v46, 0
    v_mov_b32 v47, 0
    v_mov_b32 v48, 0
    v_mov_b32 v49, 0
    v_mov_b32 v50, 0
    v_mov_b32 v51, 0
    v_mov_b32 v52, 0
    v_mov_b32 v53, 0
    v_mov_b32 v54, 0
    v_mov_b32 v55, 0
    v_mov_b32 v56, 0
    v_mov_b32 v57, 0
    v_mov_b32 v58, 0
    v_mov_b32 v59, 0
    v_mov_b32 v60, 0
    v_mov_b32 v61, 0
    v_mov_b32 v62, 0
    v_mov_b32 v63, 0
    v_mov_b32 v64, 0
    v_mov_b32 v65, 0
    v_mov_b32 v66, 0
    v_mov_b32 v67, 0
    v_mov_b32 v68, 0
    v_mov_b32 v69, 0
    v_mov_b32 v70, 0
    v_mov_b32 v71, 0
    v_mov_b32 v72, 0
    v_mov_b32 v73, 0
    v_mov_b32 v74, 0
    v_mov_b32 v75, 0
    v_mov_b32 v76, 0
    v_mov_b32 v77, 0
    v_mov_b32 v78, 0
    v_mov_b32 v79, 0
    s_mov_b32 s59, 7168
    s_mov_b32 s60, 0
    s_nop 0
kc_loop:
    s_waitcnt vmcnt(24)
    s_nop 0
    v_mfma_f32_32x32x16_bf16 v[16:31], v[96:99], v[104:107], v[16:31]
    v_mfma_f32_32x32x16_bf16 v[32:47], v[100:103], v[104:107], v[32:47]
    v_mfma_f32_32x32x16_bf16 v[48:63], v[96:99], v[108:111], v[48:63]
    v_mfma_f32_32x32x16_bf16 v[64:79], v[100:103], v[108:111], v[64:79]
    s_mov_b32 s58, s59
    s_nop 0
    buffer_load_dwordx4 v[96:99], v4, s[8:11], s58 offen offset:0
    buffer_load_dwordx4 v[100:103], v5, s[8:11], s58 offen offset:0
    buffer_load_dwordx4 v[104:107], v6, s[12:15], s58 offen offset:0
    buffer_load_dwordx4 v[108:111], v7, s[12:15], s58 offen offset:0
    s_waitcnt vmcnt(24)
    s_nop 0
    v_mfma_f32_32x32x16_bf16 v[16:31], v[112:115], v[120:123], v[16:31]
    v_mfma_f32_32x32x16_bf16 v[32:47], v[116:119], v[120:123], v[32:47]
    v_mfma_f32_32x32x16_bf16 v[48:63], v[112:115], v[124:127], v[48:63]
    v_mfma_f32_32x32x16_bf16 v[64:79], v[116:119], v[124:127], v[64:79]
    buffer_load_dwordx4 v[112:115], v4, s[8:11], s58 offen offset:1024
    buffer_load_dwordx4 v[116:119], v5, s[8:11], s58 offen offset:1024
    buffer_load_dwordx4 v[120:123], v6, s[12:15], s58 offen offset:1024
    buffer_load_dwordx4 v[124:127], v7, s[12:15], s58 offen offset:1024
    s_waitcnt vmcnt(24)
    s_nop 0
    v_mfma_f32_32x32x16_bf16 v[16:31], v[128:131], v[136:139], v[16:31]
    v_mfma_f32_32x32x16_bf16 v[32:47], v[132:135], v[136:139], v[32:47]
    v_mfma_f32_32x32x16_bf16 v[48:63], v[128:131], v[140:143], v[48:63]
    v_mfma_f32_32x32x16_bf16 v[64:79], v[132:135], v[140:143], v[64:79]
    buffer_load_dwordx4 v[128:131], v4, s[8:11], s58 offen offset:2048
    buffer_load_dwordx4 v[132:135], v5, s[8:11], s58 offen offset:2048
    buffer_load_dwordx4 v[136:139], v6, s[12:15], s58 offen offset:2048
    buffer_load_dwordx4 v[140:143], v7, s[12:15], s58 offen offset:2048
    s_waitcnt vmcnt(24)
    s_nop 0
    v_mfma_f32_32x32x16_bf16 v[16:31], v[144:147], v[152:155], v[16:31]
    v_mfma_f32_32x32x16_bf16 v[32:47], v[148:151], v[152:155], v[32:47]
    v_mfma_f32_32x32x16_bf16 v[48:63], v[144:147], v[156:159], v[48:63]
    v_mfma_f32_32x32x16_bf16 v[64:79], v[148:151], v[156:159], v[64:79]
    buffer_load_dwordx4 v[144:147], v4, s[8:11], s58 offen offset:3072
    buffer_load_dwordx4 v[148:151], v5, s[8:11], s58 offen offset:3072
    buffer_load_dwordx4 v[152:155], v6, s[12:15], s58 offen offset:3072
    buffer_load_dwordx4 v[156:159], v7, s[12:15], s58 offen offset:3072
    s_waitcnt vmcnt(24)
    s_nop 0
    v_mfma_f32_32x32x16_bf16 v[16:31], v[160:163], v[168:171], v[16:31]
    v_mfma_f32_32x32x16_bf16 v[32:47], v[164:167], v[168:171], v[32:47]
    v_mfma_f32_32x32x16_bf16 v[48:63], v[160:163], v[172:175], v[48:63]
    v_mfma_f32_32x32x16_bf16 v[64:79], v[164:167], v[172:175], v[64:79]
    s_add_u32 s58, s59, 4096
    buffer_load_dwordx4 v[160:163], v4, s[8:11], s58 offen offset:0
    buffer_load_dwordx4 v[164:167], v5, s[8:11], s58 offen offset:0
    buffer_load_dwordx4 v[168:171], v6, s[12:15], s58 offen offset:0
    buffer_load_dwordx4 v[172:175], v7, s[12:15], s58 offen offset:0
    s_waitcnt vmcnt(24)
    s_nop 0
    v_mfma_f32_32x32x16_bf16 v[16:31], v[176:179], v[184:187], v[16:31]
    v_mfma_f32_32x32x16_bf16 v[32:47], v[180:183], v[184:187], v[32:47]
    v_mfma_f32_32x32x16_bf16 v[48:63], v[176:179], v[188:191], v[48:63]
    v_mfma_f32_32x32x16_bf16 v[64:79], v[180:183], v[188:191], v[64:79]
    buffer_load_dwordx4 v[176:179], v4, s[8:11], s58 offen offset:1024
    buffer_load_dwordx4 v[180:183], v5, s[8:11], s58 offen offset:1024
    buffer_load_dwordx4 v[184:187], v6, s[12:15], s58 offen offset:1024
    buffer_load_dwordx4 v[188:191], v7, s[12:15], s58 offen offset:1024
    s_waitcnt vmcnt(24)
    s_nop 0
    v_mfma_f32_32x32x16_bf16 v[16:31], v[192:195], v[200:203], v[16:31]
    v_mfma_f32_32x32x16_bf16 v[32:47], v[196:199], v[200:203], v[32:47]
    v_mfma_f32_32x32x16_bf16 v[48:63], v[192:195], v[204:207], v[48:63]
    v_mfma_f32_32x32x16_bf16 v[64:79], v[196:199], v[204:207], v[64:79]
    buffer_load_dwordx4 v[192:195], v4, s[8:11], s58 offen offset:2048
    buffer_load_dwordx4 v[196:199], v5, s[8:11], s58 offen offset:2048
    buffer_load_dwordx4 v[200:203], v6, s[12:15], s58 offen offset:2048
    buffer_load_dwordx4 v[204:207], v7, s[12:15], s58 offen offset:2048
    s_add_u32 s59, s59, 7168
    s_add_u32 s60, s60, 1
    s_cmp_lt_u32 s60, 3
    s_cbranch_scc1 kc_loop
    s_waitcnt vmcnt(24)
    v_mfma_f32_32x32x16_bf16 v[16:31], v[96:99], v[104:107], v[16:31]
    v_mfma_f32_32x32x16_bf16 v[32:47], v[100:103], v[104:107], v[32:47]
    v_mfma_f32_32x32x16_bf16 v[48:63], v[96:99], v[108:111], v[48:63]
    v_mfma_f32_32x32x16_bf16 v[64:79], v[100:103], v[108:111], v[64:79]
    s_waitcnt vmcnt(20)
    s_nop 0
    v_mfma_f32_32x32x16_bf16 v[16:31], v[112:115], v[120:123], v[16:31]
    v_mfma_f32_32x32x16_bf16 v[32:47], v[116:119], v[120:123], v[32:47]
    v_mfma_f32_32x32x16_bf16 v[48:63], v[112:115], v[124:127], v[48:63]
    v_mfma_f32_32x32x16_bf16 v[64:79], v[116:119], v[124:127], v[64:79]
    s_waitcnt vmcnt(16)
    s_nop 0
    v_mfma_f32_32x32x16_bf16 v[16:31], v[128:131], v[136:139], v[16:31]
    v_mfma_f32_32x32x16_bf16 v[32:47], v[132:135], v[136:139], v[32:47]
    v_mfma_f32_32x32x16_bf16 v[48:63], v[128:131], v[140:143], v[48:63]
    v_mfma_f32_32x32x16_bf16 v[64:79], v[132:135], v[140:143], v[64:79]
    s_waitcnt vmcnt(12)
    s_nop 0
    v_mfma_f32_32x32x16_bf16 v[16:31], v[144:147], v[152:155], v[16:31]
    v_mfma_f32_32x32x16_bf16 v[32:47], v[148:151], v[152:155], v[32:47]
    v_mfma_f32_32x32x16_bf16 v[48:63], v[144:147], v[156:159], v[48:63]
    v_mfma_f32_32x32x16_bf16 v[64:79], v[148:151], v[156:159], v[64:79]
    s_waitcnt vmcnt(8)
    s_nop 0
    v_mfma_f32_32x32x16_bf16 v[16:31], v[160:163], v[168:171], v[16:31]
    v_mfma_f32_32x32x16_bf16 v[32:47], v[164:167], v[168:171], v[32:47]
    v_mfma_f32_32x32x16_bf16 v[48:63], v[160:163], v[172:175], v[48:63]
    v_mfma_f32_32x32x16_bf16 v[64:79], v[164:167], v[172:175], v[64:79]
    s_waitcnt vmcnt(4)
    s_nop 0
    v_mfma_f32_32x32x16_bf16 v[16:31], v[176:179], v[184:187], v[16:31]
    v_mfma_f32_32x32x16_bf16 v[32:47], v[180:183], v[184:187], v[32:47]
    v_mfma_f32_32x32x16_bf16 v[48:63], v[176:179], v[188:191], v[48:63]
    v_mfma_f32_32x32x16_bf16 v[64:79], v[180:183], v[188:191], v[64:79]
    s_waitcnt vmcnt(0)
    s_nop 0
    v_mfma_f32_32x32x16_bf16 v[16:31], v[192:195], v[200:203], v[16:31]
    v_mfma_f32_32x32x16_bf16 v[32:47], v[196:199], v[200:203], v[32:47]
    v_mfma_f32_32x32x16_bf16 v[48:63], v[192:195], v[204:207], v[48:63]
    v_mfma_f32_32x32x16_bf16 v[64:79], v[196:199], v[204:207], v[64:79]
    v_lshlrev_b32 v9, 4, v1
    s_nop 7
    s_nop 7
    s_xor_b32 s58, s4, 1
    s_mul_i32 s58, s58, 12288
    v_add_u32_e64 v10, s58, v9
    ds_write_b128 v10, v[32:35] offset:0
    ds_write_b128 v10, v[36:39] offset:1024
    ds_write_b128 v10, v[40:43] offset:2048
    ds_write_b128 v10, v[44:47] offset:3072
    s_xor_b32 s58, s4, 2
    s_mul_i32 s58, s58, 12288
    v_add_u32 v10, s58, v9
    ds_write_b128 v10, v[48:51] offset:4096
    ds_write_b128 v10, v[52:55] offset:5120
    ds_write_b128 v10, v[56:59] offset:6144
    ds_write_b128 v10, v[60:63] offset:7168
    s_xor_b32 s58, s4, 3
    s_mul_i32 s58, s58, 12288
    v_add_u32 v10, s58, v9
    ds_write_b128 v10, v[64:67] offset:8192
    ds_write_b128 v10, v[68:71] offset:9216
    ds_write_b128 v10, v[72:75] offset:10240
    ds_write_b128 v10, v[76:79] offset:11264
    s_mul_i32 s58, s4, 12288
    v_add_u32_e64 v10, s58, v9
    s_waitcnt lgkmcnt(0)
    s_barrier
    ds_read_b128 v[96:99], v10 offset:0
    ds_read_b128 v[100:103], v10 offset:1024
    ds_read_b128 v[104:107], v10 offset:2048
    ds_read_b128 v[108:111], v10 offset:3072
    ds_read_b128 v[112:115], v10 offset:4096
    ds_read_b128 v[116:119], v10 offset:5120
    ds_read_b128 v[120:123], v10 offset:6144
    ds_read_b128 v[124:127], v10 offset:7168
    ds_read_b128 v[128:131], v10 offset:8192
    ds_read_b128 v[132:135], v10 offset:9216
    ds_read_b128 v[136:139], v10 offset:10240
    ds_read_b128 v[140:143], v10 offset:11264
    s_waitcnt lgkmcnt(0)
    v_add_f32 v16, v16, v96
    v_add_f32 v112, v112, v128
    v_lshlrev_b32 v11, 16, v80
    v_add_f32 v16, v16, v11
    v_add_f32 v16, v16, v112
    v_add_f32 v17, v17, v97
    v_add_f32 v113, v113, v129
    v_and_b32 v11, 0xffff0000, v80
    v_add_f32 v17, v17, v11
    v_add_f32 v17, v17, v113
    v_add_f32 v18, v18, v98
    v_add_f32 v114, v114, v130
    v_lshlrev_b32 v11, 16, v81
    v_add_f32 v18, v18, v11
    v_add_f32 v18, v18, v114
    v_add_f32 v19, v19, v99
    v_add_f32_e64 v115, v115, v131
    v_and_b32 v11, 0xffff0000, v81
    v_add_f32 v19, v19, v11
    v_add_f32 v19, v19, v115
    v_cvt_pk_bf16_f32 v88, v16, v17
    v_cvt_pk_bf16_f32 v89, v18, v19
    v_add_f32 v20, v20, v100
    v_add_f32 v116, v116, v132
    v_lshlrev_b32 v11, 16, v82
    v_add_f32 v20, v20, v11
    v_add_f32 v20, v20, v116
    v_add_f32 v21, v21, v101
    v_add_f32_e64 v117, v117, v133
    v_and_b32 v11, 0xffff0000, v82
    v_add_f32 v21, v21, v11
    v_add_f32 v21, v21, v117
    v_add_f32 v22, v22, v102
    v_add_f32 v118, v118, v134
    v_lshlrev_b32 v11, 16, v83
    v_add_f32 v22, v22, v11
    v_add_f32 v22, v22, v118
    v_add_f32 v23, v23, v103
    v_add_f32_e64 v119, v119, v135
    v_and_b32 v11, 0xffff0000, v83
    v_add_f32 v23, v23, v11
    v_add_f32 v23, v23, v119
    v_cvt_pk_bf16_f32 v90, v20, v21
    v_cvt_pk_bf16_f32 v91, v22, v23
    s_nop 1
    v_permlane32_swap_b32 v88, v90
    v_permlane32_swap_b32 v89, v91
    s_nop 1
    buffer_store_dwordx4 v[88:91], v8, s[20:23], 0 offen offset:0 sc1
    v_add_f32 v24, v24, v104
    v_add_f32 v120, v120, v136
    v_lshlrev_b32 v11, 16, v84
    v_add_f32 v24, v24, v11
    v_add_f32 v24, v24, v120
    v_add_f32 v25, v25, v105
    v_add_f32_e64 v121, v121, v137
    v_and_b32 v11, 0xffff0000, v84
    v_add_f32 v25, v25, v11
    v_add_f32 v25, v25, v121
    v_add_f32 v26, v26, v106
    v_add_f32 v122, v122, v138
    v_lshlrev_b32 v11, 16, v85
    v_add_f32 v26, v26, v11
    v_add_f32 v26, v26, v122
    v_add_f32 v27, v27, v107
    v_add_f32_e64 v123, v123, v139
    v_and_b32 v11, 0xffff0000, v85
    v_add_f32 v27, v27, v11
    v_add_f32 v27, v27, v123
    v_cvt_pk_bf16_f32 v92, v24, v25
    v_cvt_pk_bf16_f32 v93, v26, v27
    v_add_f32 v28, v28, v108
    v_add_f32 v124, v124, v140
    v_lshlrev_b32 v11, 16, v86
    v_add_f32 v28, v28, v11
    v_add_f32 v28, v28, v124
    v_add_f32 v29, v29, v109
    v_add_f32_e64 v125, v125, v141
    v_and_b32 v11, 0xffff0000, v86
    v_add_f32 v29, v29, v11
    v_add_f32 v29, v29, v125
    v_add_f32 v30, v30, v110
    v_add_f32 v126, v126, v142
    v_lshlrev_b32 v11, 16, v87
    v_add_f32 v30, v30, v11
    v_add_f32 v30, v30, v126
    v_add_f32 v31, v31, v111
    v_add_f32_e64 v127, v127, v143
    v_and_b32 v11, 0xffff0000, v87
    v_add_f32 v31, v31, v11
    v_add_f32 v31, v31, v127
    v_cvt_pk_bf16_f32 v94, v28, v29
    v_cvt_pk_bf16_f32 v95, v30, v31
    s_nop 1
    v_permlane32_swap_b32 v92, v94
    v_permlane32_swap_b32 v93, v95
    s_nop 1
    buffer_store_dwordx4 v[92:95], v8, s[20:23], 0 offen offset:32 sc1
kc_exit:
    s_endpgm
text_end:
.section .rodata,"a"
.p2align 6
.amdhsa_kernel ka0_kernel
  .amdhsa_next_free_vgpr 212
  .amdhsa_next_free_sgpr 102
  .amdhsa_accum_offset 212
  .amdhsa_group_segment_fixed_size 0
  .amdhsa_kernarg_size 96
  .amdhsa_user_sgpr_count 2
  .amdhsa_user_sgpr_kernarg_segment_ptr 1
  .amdhsa_system_sgpr_workgroup_id_x 1
.end_amdhsa_kernel
.p2align 6
.amdhsa_kernel ks0_kernel
  .amdhsa_next_free_vgpr 168
  .amdhsa_next_free_sgpr 102
  .amdhsa_accum_offset 168
  .amdhsa_group_segment_fixed_size 0
  .amdhsa_kernarg_size 96
  .amdhsa_user_sgpr_count 2
  .amdhsa_user_sgpr_kernarg_segment_ptr 1
  .amdhsa_system_sgpr_workgroup_id_x 1
.end_amdhsa_kernel
.p2align 6
.amdhsa_kernel kb_kernel
  .amdhsa_next_free_vgpr 256
  .amdhsa_next_free_sgpr 102
  .amdhsa_accum_offset 256
  .amdhsa_group_segment_fixed_size 0
  .amdhsa_kernarg_size 96
  .amdhsa_user_sgpr_count 2
  .amdhsa_user_sgpr_kernarg_segment_ptr 1
  .amdhsa_system_sgpr_workgroup_id_x 1
.end_amdhsa_kernel
.p2align 6
.amdhsa_kernel kc0_kernel
  .amdhsa_next_free_vgpr 208
  .amdhsa_next_free_sgpr 102
  .amdhsa_accum_offset 208
  .amdhsa_group_segment_fixed_size 0
  .amdhsa_kernarg_size 96
  .amdhsa_user_sgpr_count 2
  .amdhsa_user_sgpr_kernarg_segment_ptr 1
  .amdhsa_system_sgpr_workgroup_id_x 1
.end_amdhsa_kernel
.p2align 6
.amdhsa_kernel ka1_kernel
  .amdhsa_next_free_vgpr 212
  .amdhsa_next_free_sgpr 102
  .amdhsa_accum_offset 212
  .amdhsa_group_segment_fixed_size 0
  .amdhsa_kernarg_size 96
  .amdhsa_user_sgpr_count 2
  .amdhsa_user_sgpr_kernarg_segment_ptr 1
  .amdhsa_system_sgpr_workgroup_id_x 1
.end_amdhsa_kernel
.p2align 6
.amdhsa_kernel ks1_kernel
  .amdhsa_next_free_vgpr 168
  .amdhsa_next_free_sgpr 102
  .amdhsa_accum_offset 168
  .amdhsa_group_segment_fixed_size 0
  .amdhsa_kernarg_size 96
  .amdhsa_user_sgpr_count 2
  .amdhsa_user_sgpr_kernarg_segment_ptr 1
  .amdhsa_system_sgpr_workgroup_id_x 1
.end_amdhsa_kernel
.p2align 6
.amdhsa_kernel kc1_kernel
  .amdhsa_next_free_vgpr 208
  .amdhsa_next_free_sgpr 102
  .amdhsa_accum_offset 208
  .amdhsa_group_segment_fixed_size 0
  .amdhsa_kernarg_size 96
  .amdhsa_user_sgpr_count 2
  .amdhsa_user_sgpr_kernarg_segment_ptr 1
  .amdhsa_system_sgpr_workgroup_id_x 1
.end_amdhsa_kernel
```
